```python
import torch

def _softmax(x, axis=-1):
    return torch.softmax(x, dim=axis)
def _gelu(x):
    return torch.nn.functional.gelu(x, approximate="tanh")
def _silu(x):
    return torch.nn.functional.silu(x)
def _sigmoid(x):
    return torch.sigmoid(x)
def _layernorm(x, axis=-1, eps=1e-5):
    m = x.mean(dim=axis, keepdim=True)
    v = x.var(dim=axis, keepdim=True, unbiased=False)
    return (x - m) / torch.sqrt(v + eps)
def _scatter_add(tgt, idx, src, axis=0):
    return tgt.clone().index_add_(axis, idx, src)
def _segment_sum(src, seg, n):
    out = torch.zeros((n,) + src.shape[1:], dtype=src.dtype)
    return out.index_add_(0, seg, src)
def _pad(x, pw):
    flat = tuple(v for pair in reversed(pw) for v in pair)
    return torch.nn.functional.pad(x, flat)

kernel_name = 'standalone__cross_network_dcn__recsys'

def setup_inputs():

    _w = (lambda a: (lambda t: t.to(torch.bfloat16) if t.is_floating_point() else t)(torch.as_tensor(a)))
    B, F, D, L = 1024, 26, 32, 6
    Din = min(F * D, 1024)
    return {
        "x0": _w((lambda *s: torch.randn(*s, dtype=torch.bfloat16) * 0.05)(B, Din)),
        "ws": _w((lambda *s: torch.randn(*s, dtype=torch.bfloat16) * 0.8)(L, Din, Din) * (Din ** -0.5)),
        "bs": _w((lambda *s: torch.randn(*s, dtype=torch.bfloat16) * 3.2)(L, Din) * 0.01),
    }

def reference(x0, ws, bs):
    x = x0
    L = ws.shape[0]
    for l in range(L):
        proj = torch.einsum('bd,de->be', x, ws[l]) + bs[l]
        x = x0 * proj + x
    return x
```

```asm
; @launch grid=(256,1,1) block=(256,1,1) lds=163840
.amdgcn_target "amdgcn-amd-amdhsa--gfx950"
.text
.globl standalone__cross_network_dcn__recsys_kernel
.p2align 8
.type standalone__cross_network_dcn__recsys_kernel,@function
standalone__cross_network_dcn__recsys_kernel:
    s_cmp_ge_u32 s2, 208
    s_cbranch_scc1 HELPER
    s_load_dwordx2 s[4:5], s[0:1], 0
    s_load_dwordx2 s[8:9], s[0:1], 8
    s_load_dwordx2 s[24:25], s[0:1], 40
    s_load_dwordx2 s[12:13], s[0:1], 16
    s_load_dwordx2 s[20:21], s[0:1], 32
    s_load_dwordx2 s[16:17], s[0:1], 24
    v_lshrrev_b32 v1, 6, v0
    v_and_b32 v0, 63, v0
    v_readfirstlane_b32 s28, v1
    s_lshr_b32 s29, s2, 4
    s_bfe_u32 s31, s2, 0x10003
    s_and_b32 s3, s2, 7
    s_lshl_b32 s3, s3, 1
    s_add_u32 s30, s3, s31
    s_mov_b32 s6, 1703936
    s_mov_b32 s7, 0x20000
    s_mov_b32 s10, 8306688
    s_mov_b32 s11, 0x20000
    v_lshrrev_b32 v16, 3, v0
    v_and_b32 v17, 7, v0
    s_movk_i32 s3, 1664
    s_lshl_b32 s58, s29, 7
    s_lshl_b32 s74, s28, 3
    v_add_u32 v20, s74, v16
    v_bfe_u32 v21, v20, 1, 3
    v_xor_b32 v21, v21, v17
    s_lshl_b32 s75, s30, 6
    v_add_u32 v20, s75, v20
    v_mul_u32_u24 v20, s3, v20
    v_lshl_add_u32 v5, v21, 4, v20
    v_add_u32 v241, 53248, v5
    s_lshl_b32 s72, s28, 10
    s_add_u32 s72, s72, 106496
    s_mul_i32 s71, s28, 26624
    s_add_u32 s96, s71, 13312
    s_lshl_b32 s74, s29, 1
    s_lshr_b32 s74, 0x4924924, s74
    s_and_b32 s74, s74, 3
    s_lshl_b32 s74, s74, 3
    s_lshr_b32 s74, 0x4e7278, s74
    s_mul_i32 s75, s31, 0x55
    s_xor_b32 s74, s74, s75
    s_and_b32 s75, s2, 1
    s_mul_i32 s75, s75, 0xaa
    s_xor_b32 s74, s74, s75
    v_add_u32 v22, -1, v0
    v_mul_u32_u24 v23, 43, v22
    v_lshrrev_b32 v23, 7, v23
    v_lshlrev_b32 v24, 1, v23
    v_lshrrev_b32 v24, v24, s74
    v_and_b32 v24, 3, v24
    v_sub_u32 v24, v24, v23
    v_mad_i32_i24 v22, v24, 3, v0
    v_add_u32 v22, s29, v22
    v_subrev_u32 v23, 13, v22
    v_min_u32 v22, v22, v23
    v_lshlrev_b32 v22, 7, v22
    s_lshl_b32 s74, s28, 4
    v_add_u32 v20, s74, v16
    v_mul_u32_u24 v20, s3, v20
    v_lshlrev_b32 v21, 1, v16
    v_and_b32 v21, 4, v21
    v_xor_b32 v21, v21, v17
    v_lshl_add_u32 v20, v21, 4, v20
    v_add_u32 v1, s58, v20
    v_add_u32 v2, 12288, v1
    v_readlane_b32 s59, v22, 1
    v_readlane_b32 s60, v22, 2
    v_readlane_b32 s61, v22, 3
    s_mov_b32 s14, 9984
    s_mov_b32 s15, 0x20000
    s_mov_b32 s26, 9601024
    s_mov_b32 s27, 0x20000
    s_lshl_b32 s74, s28, 1
    v_lshrrev_b32 v20, 1, v0
    v_and_b32 v21, 1, v0
    v_add_u32 v21, s74, v21
    v_lshlrev_b32 v21, 4, v21
    v_add_u32 v21, s58, v21
    v_mad_u32_u24 v246, v20, s3, v21
    s_lshl_b32 s75, s28, 10
    s_add_u32 s97, s75, 159744
    s_mul_i32 s74, s30, 266240
    s_add_u32 s74, s74, s75
    v_lshl_add_u32 v12, v0, 4, s74
    s_lshl_b32 s32, s58, 5
    v_mov_b32 v243, v12
    v_mov_b32 v248, -1
    v_mov_b32 v249, -1
    v_mov_b32 v250, -1
    v_mov_b32 v251, -1
    s_waitcnt lgkmcnt(0)
    s_add_u32 m0, s96, 0
    s_nop 0
    buffer_load_dwordx4 v241, s[4:7], s58 offen lds
    s_add_u32 m0, s72, 0
    s_nop 0
    buffer_load_dwordx4 v5, s[4:7], s58 offen lds
    s_lshl_b32 s76, s30, 11
    s_add_u32 s76, s76, 9568256
    buffer_load_dword v252, off, s[24:27], s76 offset:1920 sc1
    s_mov_b32 m0, s97
    s_nop 0
    buffer_load_dwordx4 v246, s[12:15], 0 offen lds
    buffer_store_dwordx4 v[248:251], v243, s[24:27], s32 offen sc1
    v_add_u32 v243, 53248, v243
    s_mul_i32 s46, s59, 832
    s_mul_i32 s47, s60, 832
    s_mul_i32 s48, s61, 832
    s_add_u32 m0, s71, 2048
    s_nop 0
    buffer_load_dwordx4 v1, s[8:11], s46 offen lds
    buffer_load_dwordx4 v2, s[8:11], s46 offen offset:1024 lds
    s_add_u32 m0, s71, 4096
    s_nop 0
    buffer_load_dwordx4 v1, s[8:11], s47 offen lds
    buffer_load_dwordx4 v2, s[8:11], s47 offen offset:1024 lds
    s_add_u32 m0, s71, 6144
    s_nop 0
    buffer_load_dwordx4 v1, s[8:11], s48 offen lds
    buffer_load_dwordx4 v2, s[8:11], s48 offen offset:1024 lds
    v_readlane_b32 s62, v22, 4
    v_readlane_b32 s63, v22, 5
    v_readlane_b32 s64, v22, 6
    v_readlane_b32 s65, v22, 7
    v_readlane_b32 s66, v22, 8
    v_readlane_b32 s67, v22, 9
    v_readlane_b32 s68, v22, 10
    v_readlane_b32 s69, v22, 11
    v_readlane_b32 s70, v22, 12
    s_mov_b32 s18, 1703936
    s_mov_b32 s19, 0x20000
    s_mov_b32 s22, 256
    s_mov_b32 s23, 0x20000
    s_lshl_b32 s75, s28, 11
    v_lshlrev_b32 v22, 4, v0
    v_and_b32 v18, 31, v0
    v_lshrrev_b32 v19, 5, v0
    s_add_u32 s74, s75, 106496
    v_add_u32 v10, s74, v22
    s_lshl_b32 s74, s28, 1
    v_add_u32 v20, s74, v19
    v_bfe_u32 v21, v18, 1, 3
    v_xor_b32 v21, v21, v20
    v_lshlrev_b32 v21, 4, v21
    v_lshl_add_u32 v21, v18, 7, v21
    v_add_u32 v6, 106496, v21
    v_lshrrev_b32 v23, 3, v18
    v_mul_u32_u24 v23, 25600, v23
    v_add_u32 v21, 13312, v21
    v_add_u32 v242, v21, v23
    v_lshlrev_b32 v20, 4, v20
    v_add_u32 v20, s58, v20
    s_lshl_b32 s75, s30, 6
    v_add_u32 v21, s75, v18
    v_mad_u32_u24 v13, v21, s3, v20
    v_lshl_add_u32 v14, v19, 4, s97
    v_bfe_u32 v20, v0, 4, 1
    v_xor_b32 v20, s28, v20
    v_lshlrev_b32 v20, 5, v20
    v_and_b32 v21, 1, v0
    v_lshlrev_b32 v21, 4, v21
    v_and_b32 v23, 2, v0
    v_lshlrev_b32 v23, 2, v23
    v_add3_u32 v20, v20, v21, v23
    v_and_b32 v21, 8, v0
    v_lshlrev_b32 v21, 3, v21
    v_xor_b32 v20, v20, v21
    v_bfe_u32 v21, v0, 2, 2
    v_lshl_add_u32 v21, v19, 3, v21
    v_lshlrev_b32 v21, 7, v21
    v_add3_u32 v3, v20, v21, s71
    v_xor_b32 v4, 64, v3
    s_add_u32 m0, s96, 1024
    s_nop 0
    buffer_load_dwordx4 v241, s[4:7], s59 offen lds
    s_mul_i32 s45, s58, 832
    s_mul_i32 s49, s62, 832
    s_mul_i32 s50, s63, 832
    s_mul_i32 s51, s64, 832
    s_add_u32 m0, s96, 2048
    s_nop 0
    buffer_load_dwordx4 v241, s[4:7], s60 offen lds
    s_mul_i32 s52, s65, 832
    s_mul_i32 s53, s66, 832
    s_mul_i32 s54, s67, 832
    s_mul_i32 s55, s68, 832
    s_add_u32 m0, s96, 3072
    s_nop 0
    buffer_load_dwordx4 v241, s[4:7], s61 offen lds
    s_mul_i32 s56, s69, 832
    s_mul_i32 s57, s70, 832
    s_lshl_b32 s33, s59, 5
    s_lshl_b32 s34, s60, 5
    s_add_u32 m0, s96, 4096
    s_nop 0
    buffer_load_dwordx4 v241, s[4:7], s62 offen lds
    s_lshl_b32 s35, s61, 5
    s_lshl_b32 s36, s62, 5
    s_lshl_b32 s37, s63, 5
    s_lshl_b32 s38, s64, 5
    s_add_u32 m0, s96, 5120
    s_nop 0
    buffer_load_dwordx4 v241, s[4:7], s63 offen lds
    s_lshl_b32 s39, s65, 5
    s_lshl_b32 s40, s66, 5
    s_lshl_b32 s41, s67, 5
    s_lshl_b32 s42, s68, 5
    s_add_u32 m0, s96, 6144
    s_nop 0
    buffer_load_dwordx4 v241, s[4:7], s64 offen lds
    s_lshl_b32 s43, s69, 5
    s_lshl_b32 s44, s70, 5
    v_xor_b32 v7, 2048, v10
    v_xor_b32 v8, 4096, v10
    s_add_u32 m0, s96, 7168
    s_nop 0
    buffer_load_dwordx4 v241, s[4:7], s65 offen lds
    v_xor_b32 v9, 6144, v10
    v_mov_b32 v32, 0
    v_mov_b32 v33, 0
    v_mov_b32 v34, 0
    s_add_u32 m0, s96, 8192
    s_nop 0
    buffer_load_dwordx4 v241, s[4:7], s66 offen lds
    v_mov_b32 v35, 0
    v_mov_b32 v36, 0
    v_mov_b32 v37, 0
    v_mov_b32 v38, 0
    s_add_u32 m0, s96, 9216
    s_nop 0
    buffer_load_dwordx4 v241, s[4:7], s67 offen lds
    v_mov_b32 v39, 0
    v_mov_b32 v11, v12
    v_add_u32 v240, 53248, v12
    s_mov_b32 s77, 53248
    s_add_u32 m0, s96, 10240
    s_nop 0
    buffer_load_dwordx4 v241, s[4:7], s68 offen lds
    s_mov_b32 s73, 20000
    s_getreg_b32 s79, hwreg(HW_REG_XCC_ID, 0, 4)
    s_or_b32 s79, s79, 0x80
    v_lshrrev_b32 v247, 3, v0
    s_add_u32 m0, s96, 11264
    s_nop 0
    buffer_load_dwordx4 v241, s[4:7], s69 offen lds
    v_mul_u32_u24 v247, 52224, v247
    v_add_u32 v247, v247, v12
    v_mul_u32_u24 v245, 112, v0
    v_add_u32 v247, v247, v245
    s_add_u32 m0, s96, 12288
    s_nop 0
    buffer_load_dwordx4 v241, s[4:7], s70 offen lds
    v_min_u32 v254, 12, v0
    v_lshlrev_b32 v254, 7, v254
    v_mov_b32 v253, s79
    s_add_u32 m0, s72, 4096
    s_nop 0
    buffer_load_dwordx4 v5, s[4:7], s59 offen lds
    s_add_u32 m0, s72, 8192
    s_nop 0
    buffer_load_dwordx4 v5, s[4:7], s60 offen lds
    s_add_u32 m0, s72, 12288
    s_nop 0
    buffer_load_dwordx4 v5, s[4:7], s61 offen lds
    s_add_u32 m0, s72, 16384
    s_nop 0
    buffer_load_dwordx4 v5, s[4:7], s62 offen lds
    s_add_u32 m0, s72, 20480
    s_nop 0
    buffer_load_dwordx4 v5, s[4:7], s63 offen lds
    s_add_u32 m0, s72, 24576
    s_nop 0
    buffer_load_dwordx4 v5, s[4:7], s64 offen lds
    s_waitcnt vmcnt(6)
    s_barrier
    s_add_u32 m0, s72, 28672
    s_nop 0
    buffer_load_dwordx4 v5, s[4:7], s65 offen lds
    ds_read_b128 v[188:191], v242 offset:0
    ds_read_b128 v[192:195], v242 offset:1024
    ds_read_b128 v[196:199], v242 offset:2048
    ds_read_b128 v[200:203], v242 offset:3072
    s_add_u32 m0, s72, 32768
    s_nop 0
    buffer_load_dwordx4 v5, s[4:7], s66 offen lds
    ds_read_b128 v[204:207], v242 offset:4096
    ds_read_b128 v[208:211], v242 offset:5120
    ds_read_b128 v[212:215], v242 offset:6144
    ds_read_b128 v[216:219], v242 offset:7168
    s_add_u32 m0, s72, 36864
    s_nop 0
    buffer_load_dwordx4 v5, s[4:7], s67 offen lds
    ds_read_b128 v[220:223], v242 offset:8192
    ds_read_b128 v[224:227], v242 offset:9216
    ds_read_b128 v[228:231], v242 offset:10240
    ds_read_b128 v[232:235], v242 offset:11264
    s_add_u32 m0, s72, 40960
    s_nop 0
    buffer_load_dwordx4 v5, s[4:7], s68 offen lds
    ds_read_b128 v[236:239], v242 offset:12288
    ds_read_b128 v[16:19], v14 offset:0
    s_add_u32 m0, s72, 45056
    s_nop 0
    buffer_load_dwordx4 v5, s[4:7], s69 offen lds
    s_add_u32 m0, s72, 49152
    s_nop 0
    buffer_load_dwordx4 v5, s[4:7], s70 offen lds
    s_waitcnt lgkmcnt(1)
    s_barrier
    s_add_u32 m0, s71, 20480
    s_nop 0
    buffer_load_dwordx4 v1, s[8:11], s55 offen lds
    ds_read_b64_tr_b16 a[12:13], v4 offset:2048
    ds_read_b64_tr_b16 a[14:15], v4 offset:2560
    buffer_load_dwordx4 v2, s[8:11], s55 offen offset:1024 lds
    ds_read_b64_tr_b16 a[8:9], v3 offset:2048
    ds_read_b64_tr_b16 a[10:11], v3 offset:2560
    s_add_u32 m0, s71, 22528
    s_nop 0
    buffer_load_dwordx4 v1, s[8:11], s56 offen lds
    ds_read_b64_tr_b16 a[20:21], v4 offset:4096
    ds_read_b64_tr_b16 a[22:23], v4 offset:4608
    buffer_load_dwordx4 v2, s[8:11], s56 offen offset:1024 lds
    ds_read_b64_tr_b16 a[16:17], v3 offset:4096
    ds_read_b64_tr_b16 a[18:19], v3 offset:4608
    s_add_u32 m0, s71, 24576
    s_nop 0
    buffer_load_dwordx4 v1, s[8:11], s57 offen lds
    ds_read_b64_tr_b16 a[28:29], v4 offset:6144
    ds_read_b64_tr_b16 a[30:31], v4 offset:6656
    buffer_load_dwordx4 v2, s[8:11], s57 offen offset:1024 lds
    ds_read_b64_tr_b16 a[24:25], v3 offset:6144
    ds_read_b64_tr_b16 a[26:27], v3 offset:6656
    s_waitcnt vmcnt(6)
    s_barrier
    s_add_u32 m0, s71, 14336
    s_nop 0
    buffer_load_dwordx4 v1, s[8:11], s52 offen lds
    ds_read_b128 v[136:139], v6 offset:0
    ds_read_b128 v[140:143], v6 offset:4096
    ds_read_b128 v[144:147], v6 offset:8192
    ds_read_b128 v[148:151], v6 offset:12288
    ds_read_b128 v[152:155], v6 offset:16384
    buffer_load_dwordx4 v2, s[8:11], s52 offen offset:1024 lds
    ds_read_b128 v[156:159], v6 offset:20480
    ds_read_b128 v[160:163], v6 offset:24576
    ds_read_b128 v[164:167], v6 offset:28672
    ds_read_b128 v[168:171], v6 offset:32768
    ds_read_b128 v[172:175], v6 offset:36864
    s_add_u32 m0, s71, 16384
    s_nop 0
    buffer_load_dwordx4 v1, s[8:11], s53 offen lds
    ds_read_b128 v[176:179], v6 offset:40960
    ds_read_b128 v[180:183], v6 offset:45056
    ds_read_b128 v[184:187], v6 offset:49152
    s_waitcnt lgkmcnt(15)
    v_lshlrev_b32 v24, 16, v16
    buffer_load_dwordx4 v2, s[8:11], s53 offen offset:1024 lds
    v_and_b32 v25, 0xffff0000, v16
    v_lshlrev_b32 v26, 16, v17
    v_and_b32 v27, 0xffff0000, v17
    v_lshlrev_b32 v28, 16, v18
    v_and_b32 v29, 0xffff0000, v18
    s_add_u32 m0, s71, 18432
    s_nop 0
    buffer_load_dwordx4 v1, s[8:11], s54 offen lds
    v_lshlrev_b32 v30, 16, v19
    v_and_b32 v31, 0xffff0000, v19
    v_lshlrev_b32 v48, 16, v188
    v_and_b32 v49, 0xffff0000, v188
    v_lshlrev_b32 v50, 16, v189
    buffer_load_dwordx4 v2, s[8:11], s54 offen offset:1024 lds
    v_and_b32 v51, 0xffff0000, v189
    v_lshlrev_b32 v52, 16, v190
    v_and_b32 v53, 0xffff0000, v190
    v_lshlrev_b32 v54, 16, v191
    v_and_b32 v55, 0xffff0000, v191
    s_add_u32 m0, s71, 0
    s_nop 0
    buffer_load_dwordx4 v1, s[8:11], s45 offen lds
    v_lshlrev_b32 v64, 16, v188
    v_and_b32 v65, 0xffff0000, v188
    v_lshlrev_b32 v66, 16, v189
    v_and_b32 v67, 0xffff0000, v189
    v_lshlrev_b32 v68, 16, v190
    buffer_load_dwordx4 v2, s[8:11], s45 offen offset:1024 lds
    v_and_b32 v69, 0xffff0000, v190
    v_lshlrev_b32 v70, 16, v191
    v_and_b32 v71, 0xffff0000, v191
    s_waitcnt lgkmcnt(0)
    v_lshlrev_b32 v40, 16, v136
    s_add_u32 m0, s71, 8192
    s_nop 0
    buffer_load_dwordx4 v1, s[8:11], s49 offen lds
    v_and_b32 v41, 0xffff0000, v136
    v_lshlrev_b32 v42, 16, v137
    v_and_b32 v43, 0xffff0000, v137
    v_lshlrev_b32 v44, 16, v138
    v_and_b32 v45, 0xffff0000, v138
    buffer_load_dwordx4 v2, s[8:11], s49 offen offset:1024 lds
    v_lshlrev_b32 v46, 16, v139
    v_and_b32 v47, 0xffff0000, v139
    v_lshlrev_b32 v56, 16, v136
    v_and_b32 v57, 0xffff0000, v136
    v_lshlrev_b32 v58, 16, v137
    s_add_u32 m0, s71, 10240
    s_nop 0
    buffer_load_dwordx4 v1, s[8:11], s50 offen lds
    v_and_b32 v59, 0xffff0000, v137
    v_lshlrev_b32 v60, 16, v138
    v_and_b32 v61, 0xffff0000, v138
    v_lshlrev_b32 v62, 16, v139
    v_and_b32 v63, 0xffff0000, v139
    buffer_load_dwordx4 v2, s[8:11], s50 offen offset:1024 lds
    s_waitcnt vmcnt(16)
    ds_read_b64_tr_b16 a[84:85], v4 offset:20480
    ds_read_b64_tr_b16 a[86:87], v4 offset:20992
    ds_read_b64_tr_b16 a[80:81], v3 offset:20480
    ds_read_b64_tr_b16 a[82:83], v3 offset:20992
    s_waitcnt vmcnt(14)
    ds_read_b64_tr_b16 a[92:93], v4 offset:22528
    s_add_u32 m0, s71, 12288
    s_nop 0
    buffer_load_dwordx4 v1, s[8:11], s51 offen lds
    ds_read_b64_tr_b16 a[94:95], v4 offset:23040
    ds_read_b64_tr_b16 a[88:89], v3 offset:22528
    ds_read_b64_tr_b16 a[90:91], v3 offset:23040
    s_waitcnt vmcnt(13)
    ds_read_b64_tr_b16 a[100:101], v4 offset:24576
    ds_read_b64_tr_b16 a[102:103], v4 offset:25088
    buffer_load_dwordx4 v2, s[8:11], s51 offen offset:1024 lds
    ds_read_b64_tr_b16 a[96:97], v3 offset:24576
    ds_read_b64_tr_b16 a[98:99], v3 offset:25088
    s_lshl_b32 s3, s28, 28
    s_add_u32 s3, s3, s58
    v_add_u32 v252, 0x3c6ef373, v252
    v_mov_b32 v15, s3
    s_mov_b64 exec, 1
    buffer_store_dwordx2 v[252:253], v15, s[24:27], s76 offen sc1
    s_mov_b64 exec, -1
    s_nop 3
    v_mfma_f32_32x32x16_bf16 v[88:103], a[12:15], v[140:143], 0
    buffer_store_dwordx4 v[248:251], v243, s[24:27], s32 offen sc1
    v_add_u32 v243, 53248, v243
    s_waitcnt vmcnt(14)
    ds_read_b64_tr_b16 a[60:61], v4 offset:14336
    ds_read_b64_tr_b16 a[62:63], v4 offset:14848
    v_mfma_f32_32x32x16_bf16 v[72:87], a[8:11], v[140:143], v[24:39]
    s_add_u32 m0, s71, 2048
    s_add_u32 s46, s46, 1384448
    buffer_load_dwordx4 v1, s[8:11], s46 offen lds
    ds_read_b64_tr_b16 a[56:57], v3 offset:14336
    ds_read_b64_tr_b16 a[58:59], v3 offset:14848
    v_mfma_f32_32x32x16_bf16 v[88:103], a[20:23], v[144:147], v[88:103]
    buffer_load_dwordx4 v2, s[8:11], s46 offen offset:1024 lds
    s_waitcnt vmcnt(14)
    ds_read_b64_tr_b16 a[68:69], v4 offset:16384
    ds_read_b64_tr_b16 a[70:71], v4 offset:16896
    v_mfma_f32_32x32x16_bf16 v[72:87], a[16:19], v[144:147], v[72:87]
    s_add_u32 m0, s71, 4096
    s_add_u32 s47, s47, 1384448
    buffer_load_dwordx4 v1, s[8:11], s47 offen lds
    ds_read_b64_tr_b16 a[64:65], v3 offset:16384
    v_mfma_f32_32x32x16_bf16 v[88:103], a[28:31], v[148:151], v[88:103]
    buffer_load_dwordx4 v2, s[8:11], s47 offen offset:1024 lds
    ds_read_b64_tr_b16 a[66:67], v3 offset:16896
    s_waitcnt vmcnt(14)
    ds_read_b64_tr_b16 a[76:77], v4 offset:18432
    v_mfma_f32_32x32x16_bf16 v[72:87], a[24:27], v[148:151], v[72:87]
    s_add_u32 m0, s71, 6144
    s_add_u32 s48, s48, 1384448
    buffer_load_dwordx4 v1, s[8:11], s48 offen lds
    ds_read_b64_tr_b16 a[78:79], v4 offset:18944
    ds_read_b64_tr_b16 a[72:73], v3 offset:18432
    s_waitcnt lgkmcnt(15)
    v_mfma_f32_32x32x16_bf16 v[88:103], a[84:87], v[176:179], v[88:103]
    ds_read_b64_tr_b16 a[74:75], v3 offset:18944
    s_waitcnt vmcnt(13)
    ds_read_b64_tr_b16 a[4:5], v4 offset:0
    v_mfma_f32_32x32x16_bf16 v[72:87], a[80:83], v[176:179], v[72:87]
    buffer_load_dwordx4 v2, s[8:11], s48 offen offset:1024 lds
    ds_read_b64_tr_b16 a[6:7], v4 offset:512
    v_mfma_f32_32x32x16_bf16 v[88:103], a[92:95], v[180:183], v[88:103]
    s_waitcnt lgkmcnt(10)
    s_add_u32 m0, s71, 14336
    s_add_u32 s52, s52, 1384448
    buffer_load_dwordx4 v1, s[8:11], s52 offen lds
    ds_read_b64_tr_b16 a[0:1], v3 offset:0
    ds_read_b64_tr_b16 a[2:3], v3 offset:512
    v_mfma_f32_32x32x16_bf16 v[72:87], a[88:91], v[180:183], v[72:87]
    buffer_load_dwordx4 v2, s[8:11], s52 offen offset:1024 lds
    s_waitcnt vmcnt(14)
    ds_read_b64_tr_b16 a[36:37], v4 offset:8192
    ds_read_b64_tr_b16 a[38:39], v4 offset:8704
    v_mfma_f32_32x32x16_bf16 v[88:103], a[100:103], v[184:187], v[88:103]
    buffer_load_dwordx2 v[20:21], v254, s[24:27], s76 offen sc1
    ds_read_b64_tr_b16 a[32:33], v3 offset:8192
    ds_read_b64_tr_b16 a[34:35], v3 offset:8704
    v_mfma_f32_32x32x16_bf16 v[72:87], a[96:99], v[184:187], v[72:87]
    s_waitcnt lgkmcnt(12)
    s_add_u32 m0, s71, 16384
    s_add_u32 s53, s53, 1384448
    buffer_load_dwordx4 v1, s[8:11], s53 offen lds
    s_waitcnt vmcnt(14)
    ds_read_b64_tr_b16 a[44:45], v4 offset:10240
    v_mfma_f32_32x32x16_bf16 v[88:103], a[60:63], v[164:167], v[88:103]
    ds_read_b64_tr_b16 a[46:47], v4 offset:10752
    ds_read_b64_tr_b16 a[40:41], v3 offset:10240
    v_mfma_f32_32x32x16_bf16 v[72:87], a[56:59], v[164:167], v[72:87]
    buffer_load_dwordx4 v2, s[8:11], s53 offen offset:1024 lds
    ds_read_b64_tr_b16 a[42:43], v3 offset:10752
    s_waitcnt vmcnt(13)
    ds_read_b64_tr_b16 a[52:53], v4 offset:12288
    v_mfma_f32_32x32x16_bf16 v[88:103], a[68:71], v[168:171], v[88:103]
    s_waitcnt lgkmcnt(13)
    s_add_u32 m0, s71, 18432
    s_add_u32 s54, s54, 1384448
    buffer_load_dwordx4 v1, s[8:11], s54 offen lds
    ds_read_b64_tr_b16 a[54:55], v4 offset:12800
    ds_read_b64_tr_b16 a[48:49], v3 offset:12288
    v_mfma_f32_32x32x16_bf16 v[72:87], a[64:67], v[168:171], v[72:87]
    buffer_load_dwordx4 v2, s[8:11], s54 offen offset:1024 lds
    ds_read_b64_tr_b16 a[50:51], v3 offset:12800
    v_mfma_f32_32x32x16_bf16 v[88:103], a[76:79], v[172:175], v[88:103]
    s_waitcnt lgkmcnt(12)
    s_add_u32 m0, s71, 0
    s_add_u32 s45, s45, 1384448
    buffer_load_dwordx4 v1, s[8:11], s45 offen lds
    v_mfma_f32_32x32x16_bf16 v[72:87], a[72:75], v[172:175], v[72:87]
    buffer_load_dwordx4 v2, s[8:11], s45 offen offset:1024 lds
    v_mfma_f32_32x32x16_bf16 v[88:103], a[4:7], v[136:139], v[88:103]
    s_waitcnt lgkmcnt(8)
    s_add_u32 m0, s71, 8192
    s_add_u32 s49, s49, 1384448
    buffer_load_dwordx4 v1, s[8:11], s49 offen lds
    v_mfma_f32_32x32x16_bf16 v[72:87], a[0:3], v[136:139], v[72:87]
    v_mfma_f32_32x32x16_bf16 v[88:103], a[36:39], v[152:155], v[88:103]
    buffer_load_dwordx4 v2, s[8:11], s49 offen offset:1024 lds
    s_waitcnt lgkmcnt(6)
    v_mfma_f32_32x32x16_bf16 v[88:103], a[44:47], v[156:159], v[88:103]
    s_waitcnt lgkmcnt(4)
    s_add_u32 m0, s71, 10240
    s_add_u32 s50, s50, 1384448
    buffer_load_dwordx4 v1, s[8:11], s50 offen lds
    s_barrier
    s_waitcnt lgkmcnt(2)
    v_mfma_f32_32x32x16_bf16 v[88:103], a[52:55], v[160:163], v[88:103]
    buffer_load_dwordx4 v2, s[8:11], s50 offen offset:1024 lds
    v_mfma_f32_32x32x16_bf16 v[72:87], a[32:35], v[152:155], v[72:87]
    s_waitcnt lgkmcnt(0)
    s_add_u32 m0, s71, 12288
    s_add_u32 s51, s51, 1384448
    buffer_load_dwordx4 v1, s[8:11], s51 offen lds
    v_mfma_f32_32x32x16_bf16 v[72:87], a[40:43], v[156:159], v[72:87]
    s_nop 4
    ds_write_b128 v8, v[88:91] offset:8192
    ds_write_b128 v8, v[92:95] offset:9216
    buffer_load_dwordx4 v2, s[8:11], s51 offen offset:1024 lds
    v_mfma_f32_32x32x16_bf16 v[72:87], a[48:51], v[160:163], v[72:87]
    ds_write_b128 v9, v[96:99] offset:16384
    ds_write_b128 v9, v[100:103] offset:17408
    v_mfma_f32_32x32x16_bf16 v[120:135], a[4:7], v[188:191], 0
    s_add_u32 m0, s71, 20480
    s_add_u32 s55, s55, 1384448
    buffer_load_dwordx4 v1, s[8:11], s55 offen lds
    buffer_load_dwordx4 v2, s[8:11], s55 offen offset:1024 lds
    s_waitcnt vmcnt(21)
    ds_read_b64_tr_b16 a[116:117], v4 offset:2048
    ds_read_b64_tr_b16 a[118:119], v4 offset:2560
    v_mfma_f32_32x32x16_bf16 v[104:119], a[0:3], v[188:191], v[24:39]
    s_nop 0
    ds_write_b128 v7, v[80:83] offset:0
    ds_write_b128 v7, v[84:87] offset:1024
    s_add_u32 m0, s71, 22528
    s_add_u32 s56, s56, 1384448
    buffer_load_dwordx4 v1, s[8:11], s56 offen lds
    buffer_load_dwordx4 v2, s[8:11], s56 offen offset:1024 lds
    v_fma_f32 v56, v40, v72, v56
    v_fma_f32 v57, v41, v73, v57
    v_fma_f32 v58, v42, v74, v58
    v_fma_f32 v59, v43, v75, v59
    v_fma_f32 v60, v44, v76, v60
    v_fma_f32 v61, v45, v77, v61
    v_fma_f32 v62, v46, v78, v62
    v_fma_f32 v63, v47, v79, v63
    ds_read_b64_tr_b16 a[112:113], v3 offset:2048
    ds_read_b64_tr_b16 a[114:115], v3 offset:2560
    v_mfma_f32_32x32x16_bf16 v[120:135], a[12:15], v[192:195], v[120:135]
    s_add_u32 m0, s71, 24576
    s_add_u32 s57, s57, 1384448
    buffer_load_dwordx4 v1, s[8:11], s57 offen lds
    buffer_load_dwordx4 v2, s[8:11], s57 offen offset:1024 lds
    s_waitcnt lgkmcnt(2)
    s_barrier
    ds_read_b128 v[88:91], v10 offset:8192
    ds_read_b128 v[96:99], v10 offset:16384
    ds_read_b128 v[80:83], v10 offset:0
    s_waitcnt vmcnt(23)
    ds_read_b64_tr_b16 a[124:125], v4 offset:4096
    ds_read_b64_tr_b16 a[126:127], v4 offset:4608
    v_mfma_f32_32x32x16_bf16 v[104:119], a[8:11], v[192:195], v[104:119]
    ds_read_b128 v[92:95], v10 offset:9216
    ds_read_b128 v[100:103], v10 offset:17408
    ds_read_b128 v[84:87], v10 offset:1024
    s_waitcnt lgkmcnt(8)
    s_add_u32 m0, s71, 2048
    s_add_u32 s46, s46, 1384448
    buffer_load_dwordx4 v1, s[8:11], s46 offen lds
    buffer_load_dwordx4 v2, s[8:11], s46 offen offset:1024 lds
    ds_read_b64_tr_b16 a[120:121], v3 offset:4096
    ds_read_b64_tr_b16 a[122:123], v3 offset:4608
    v_mfma_f32_32x32x16_bf16 v[120:135], a[20:23], v[196:199], v[120:135]
    s_waitcnt lgkmcnt(9)
    v_fma_f32 v56, v40, v88, v56
    v_fma_f32 v57, v41, v89, v57
    v_fma_f32 v58, v42, v90, v58
    v_fma_f32 v59, v43, v91, v59
    s_waitcnt lgkmcnt(8)
    v_fma_f32 v56, v40, v96, v56
    v_fma_f32 v57, v41, v97, v57
    v_fma_f32 v58, v42, v98, v58
    v_fma_f32 v59, v43, v99, v59
    s_waitcnt lgkmcnt(7)
    v_fma_f32 v56, v40, v80, v56
    v_fma_f32 v57, v41, v81, v57
    v_fma_f32 v58, v42, v82, v58
    v_fma_f32 v59, v43, v83, v59
    v_cvt_pk_bf16_f32 v136, v56, v57
    v_cvt_pk_bf16_f32 v137, v58, v59
    v_min_u32 v136, -2, v136
    s_waitcnt lgkmcnt(0)
    s_add_u32 m0, s71, 4096
    s_add_u32 s47, s47, 1384448
    buffer_load_dwordx4 v1, s[8:11], s47 offen lds
    s_waitcnt vmcnt(24)
    ds_read_b64_tr_b16 a[132:133], v4 offset:6144
    ds_read_b64_tr_b16 a[134:135], v4 offset:6656
    v_mfma_f32_32x32x16_bf16 v[104:119], a[16:19], v[196:199], v[104:119]
    v_fma_f32 v60, v44, v92, v60
    v_fma_f32 v61, v45, v93, v61
    v_fma_f32 v62, v46, v94, v62
    v_fma_f32 v63, v47, v95, v63
    v_fma_f32 v60, v44, v100, v60
    v_fma_f32 v61, v45, v101, v61
    v_fma_f32 v62, v46, v102, v62
    v_fma_f32 v63, v47, v103, v63
    v_fma_f32 v60, v44, v84, v60
    v_fma_f32 v61, v45, v85, v61
    v_fma_f32 v62, v46, v86, v62
    v_fma_f32 v63, v47, v87, v63
    v_cvt_pk_bf16_f32 v138, v60, v61
    v_cvt_pk_bf16_f32 v139, v62, v63
    v_min_u32 v138, -2, v138
    s_waitcnt vmcnt(21)
FCK:
    v_cmp_ne_u32 vcc, v252, v20
    s_cbranch_vccnz FRT
    v_cmp_ne_u32 vcc, v253, v21
    s_or_b32 s78, vcc_lo, vcc_hi
    s_cmp_lg_u32 s78, 0
    s_cbranch_scc1 DS0A
    buffer_store_dwordx4 v[136:139], v12, s[24:27], s32 offen
DS0B:
    v_add_u32 v12, 53248, v12
    ds_read_b64_tr_b16 a[128:129], v3 offset:6144
    ds_read_b64_tr_b16 a[130:131], v3 offset:6656
    v_mfma_f32_32x32x16_bf16 v[120:135], a[28:31], v[200:203], v[120:135]
    s_cmp_lg_u32 s78, 0
    s_cbranch_scc1 PS2A
    buffer_store_dwordx4 v[248:251], v243, s[24:27], s32 offen
PS2B:
    v_add_u32 v243, 53248, v243
    s_waitcnt vmcnt(17)
    ds_read_b64_tr_b16 a[108:109], v4 offset:0
    ds_read_b64_tr_b16 a[110:111], v4 offset:512
    v_mfma_f32_32x32x16_bf16 v[104:119], a[24:27], v[200:203], v[104:119]
    buffer_load_dwordx4 v2, s[8:11], s47 offen offset:1024 lds
    ds_read_b64_tr_b16 a[104:105], v3 offset:0
    ds_read_b64_tr_b16 a[106:107], v3 offset:512
    v_mfma_f32_32x32x16_bf16 v[120:135], a[36:39], v[204:207], v[120:135]
    ds_read_b64_tr_b16 a[164:165], v4 offset:14336
    ds_read_b64_tr_b16 a[166:167], v4 offset:14848
    v_mfma_f32_32x32x16_bf16 v[104:119], a[32:35], v[204:207], v[104:119]
    s_waitcnt lgkmcnt(6)
    s_add_u32 m0, s71, 6144
    s_add_u32 s48, s48, 1384448
    buffer_load_dwordx4 v1, s[8:11], s48 offen lds
    ds_read_b64_tr_b16 a[160:161], v3 offset:14336
    ds_read_b64_tr_b16 a[162:163], v3 offset:14848
    v_mfma_f32_32x32x16_bf16 v[120:135], a[44:47], v[208:211], v[120:135]
    buffer_load_dwordx4 v2, s[8:11], s48 offen offset:1024 lds
    ds_read_b64_tr_b16 a[172:173], v4 offset:16384
    ds_read_b64_tr_b16 a[174:175], v4 offset:16896
    v_mfma_f32_32x32x16_bf16 v[104:119], a[40:43], v[208:211], v[104:119]
    ds_read_b64_tr_b16 a[168:169], v3 offset:16384
    ds_read_b64_tr_b16 a[170:171], v3 offset:16896
    v_mfma_f32_32x32x16_bf16 v[120:135], a[52:55], v[212:215], v[120:135]
    s_waitcnt lgkmcnt(8)
    s_add_u32 m0, s71, 0
    s_add_u32 s45, s45, 1384448
    buffer_load_dwordx4 v1, s[8:11], s45 offen lds
    ds_read_b64_tr_b16 a[180:181], v4 offset:18432
    ds_read_b64_tr_b16 a[182:183], v4 offset:18944
    v_mfma_f32_32x32x16_bf16 v[104:119], a[48:51], v[212:215], v[104:119]
    buffer_load_dwordx4 v2, s[8:11], s45 offen offset:1024 lds
    ds_read_b64_tr_b16 a[176:177], v3 offset:18432
    ds_read_b64_tr_b16 a[178:179], v3 offset:18944
    v_mfma_f32_32x32x16_bf16 v[120:135], a[60:63], v[216:219], v[120:135]
    s_waitcnt vmcnt(20)
    ds_read_b64_tr_b16 a[140:141], v4 offset:8192
    ds_read_b64_tr_b16 a[142:143], v4 offset:8704
    ds_read_b128 v[16:19], v14 offset:32
    v_mfma_f32_32x32x16_bf16 v[104:119], a[56:59], v[216:219], v[104:119]
    buffer_load_dwordx4 v[140:143], v11, s[24:27], s33 offen sc1
    ds_read_b64_tr_b16 a[136:137], v3 offset:8192
    ds_read_b64_tr_b16 a[138:139], v3 offset:8704
    v_mfma_f32_32x32x16_bf16 v[120:135], a[68:71], v[220:223], v[120:135]
    buffer_load_dwordx4 v[144:147], v11, s[24:27], s34 offen sc1
    s_waitcnt vmcnt(20)
    ds_read_b64_tr_b16 a[148:149], v4 offset:10240
    ds_read_b64_tr_b16 a[150:151], v4 offset:10752
    v_mfma_f32_32x32x16_bf16 v[104:119], a[64:67], v[220:223], v[104:119]
    ds_read_b64_tr_b16 a[144:145], v3 offset:10240
    ds_read_b64_tr_b16 a[146:147], v3 offset:10752
    v_mfma_f32_32x32x16_bf16 v[120:135], a[76:79], v[224:227], v[120:135]
    buffer_load_dwordx4 v[148:151], v11, s[24:27], s35 offen sc1
    s_waitcnt vmcnt(19)
    ds_read_b64_tr_b16 a[156:157], v4 offset:12288
    ds_read_b64_tr_b16 a[158:159], v4 offset:12800
    v_mfma_f32_32x32x16_bf16 v[104:119], a[72:75], v[224:227], v[104:119]
    buffer_load_dwordx4 v[152:155], v11, s[24:27], s36 offen sc1
    ds_read_b64_tr_b16 a[152:153], v3 offset:12288
    ds_read_b64_tr_b16 a[154:155], v3 offset:12800
    v_mfma_f32_32x32x16_bf16 v[120:135], a[84:87], v[228:231], v[120:135]
    v_mfma_f32_32x32x16_bf16 v[120:135], a[92:95], v[232:235], v[120:135]
    buffer_load_dwordx4 v[156:159], v11, s[24:27], s37 offen sc1
    s_waitcnt lgkmcnt(10)
    v_lshlrev_b32 v24, 16, v16
    v_and_b32 v25, 0xffff0000, v16
    v_mfma_f32_32x32x16_bf16 v[120:135], a[100:103], v[236:239], v[120:135]
    buffer_load_dwordx4 v[160:163], v11, s[24:27], s38 offen sc1
    v_lshlrev_b32 v26, 16, v17
    v_and_b32 v27, 0xffff0000, v17
    v_lshlrev_b32 v28, 16, v18
    v_mfma_f32_32x32x16_bf16 v[104:119], a[80:83], v[228:231], v[104:119]
    v_and_b32 v29, 0xffff0000, v18
    v_lshlrev_b32 v30, 16, v19
    v_and_b32 v31, 0xffff0000, v19
    v_mfma_f32_32x32x16_bf16 v[104:119], a[88:91], v[232:235], v[104:119]
    s_nop 2
    ds_write_b128 v8, v[120:123] offset:32768
    ds_write_b128 v8, v[124:127] offset:33792
    buffer_load_dwordx4 v[164:167], v11, s[24:27], s39 offen sc1
    v_mfma_f32_32x32x16_bf16 v[104:119], a[96:99], v[236:239], v[104:119]
    ds_write_b128 v9, v[128:131] offset:40960
    ds_write_b128 v9, v[132:135] offset:41984
    v_mfma_f32_32x32x16_bf16 v[88:103], a[108:111], v[136:139], 0
    buffer_load_dwordx4 v[168:171], v11, s[24:27], s40 offen sc1
    buffer_load_dwordx4 v[172:175], v11, s[24:27], s41 offen sc1
    v_mfma_f32_32x32x16_bf16 v[72:87], a[104:107], v[136:139], v[24:39]
    s_nop 5
    ds_write_b128 v7, v[112:115] offset:24576
    ds_write_b128 v7, v[116:119] offset:25600
    buffer_load_dwordx4 v[176:179], v11, s[24:27], s42 offen sc1
    buffer_load_dwordx4 v[180:183], v11, s[24:27], s43 offen sc1
    s_waitcnt vmcnt(9)
    v_max3_u32 v15, v140, v142, v144
    v_max_u32 v15, v15, v146
    v_cmp_eq_u32 vcc, -1, v15
    v_fma_f32 v64, v48, v104, v64
    v_fma_f32 v65, v49, v105, v65
    v_fma_f32 v66, v50, v106, v66
    v_fma_f32 v67, v51, v107, v67
    v_fma_f32 v68, v52, v108, v68
    v_fma_f32 v69, v53, v109, v69
    v_fma_f32 v70, v54, v110, v70
    v_fma_f32 v71, v55, v111, v71
    s_cbranch_vccz C1_0_1K
C1_0_1R:
    buffer_load_dwordx4 v[140:143], v11, s[24:27], s33 offen sc1
    buffer_load_dwordx4 v[144:147], v11, s[24:27], s34 offen sc1
    s_sub_u32 s73, s73, 1
    s_cbranch_scc1 END
    s_waitcnt vmcnt(0)
    v_max3_u32 v15, v140, v142, v144
    v_max_u32 v15, v15, v146
    v_cmp_eq_u32 vcc, -1, v15
    s_cbranch_vccnz C1_0_1R
C1_0_1K:
    v_mfma_f32_32x32x16_bf16 v[88:103], a[116:119], v[140:143], v[88:103]
    buffer_load_dwordx4 v[184:187], v11, s[24:27], s44 offen sc1
    s_add_u32 m0, s71, 14336
    s_add_u32 s52, s52, 1384448
    buffer_load_dwordx4 v1, s[8:11], s52 offen lds
    s_waitcnt lgkmcnt(0)
    s_barrier
    ds_read_b128 v[120:123], v10 offset:32768
    ds_read_b128 v[128:131], v10 offset:40960
    ds_read_b128 v[112:115], v10 offset:24576
    v_mfma_f32_32x32x16_bf16 v[72:87], a[112:115], v[140:143], v[72:87]
    ds_read_b128 v[124:127], v10 offset:33792
    ds_read_b128 v[132:135], v10 offset:41984
    ds_read_b128 v[116:119], v10 offset:25600
    buffer_load_dwordx4 v2, s[8:11], s52 offen offset:1024 lds
    s_add_u32 m0, s71, 16384
    s_add_u32 s53, s53, 1384448
    buffer_load_dwordx4 v1, s[8:11], s53 offen lds
    v_mfma_f32_32x32x16_bf16 v[88:103], a[124:127], v[144:147], v[88:103]
    s_waitcnt lgkmcnt(5)
    v_fma_f32 v64, v48, v120, v64
    v_fma_f32 v65, v49, v121, v65
    v_fma_f32 v66, v50, v122, v66
    v_fma_f32 v67, v51, v123, v67
    s_waitcnt lgkmcnt(4)
    v_fma_f32 v64, v48, v128, v64
    v_fma_f32 v65, v49, v129, v65
    v_fma_f32 v66, v50, v130, v66
    v_fma_f32 v67, v51, v131, v67
    s_waitcnt lgkmcnt(3)
    v_fma_f32 v64, v48, v112, v64
    v_fma_f32 v65, v49, v113, v65
    v_fma_f32 v66, v50, v114, v66
    v_fma_f32 v67, v51, v115, v67
    v_cvt_pk_bf16_f32 v188, v64, v65
    v_cvt_pk_bf16_f32 v189, v66, v67
    v_min_u32 v188, -2, v188
    buffer_load_dwordx4 v2, s[8:11], s53 offen offset:1024 lds
    v_mfma_f32_32x32x16_bf16 v[72:87], a[120:123], v[144:147], v[72:87]
    s_waitcnt lgkmcnt(2)
    v_fma_f32 v68, v52, v124, v68
    v_fma_f32 v69, v53, v125, v69
    v_fma_f32 v70, v54, v126, v70
    v_fma_f32 v71, v55, v127, v71
    s_waitcnt lgkmcnt(1)
    v_fma_f32 v68, v52, v132, v68
    v_fma_f32 v69, v53, v133, v69
    v_fma_f32 v70, v54, v134, v70
    v_fma_f32 v71, v55, v135, v71
    s_waitcnt lgkmcnt(0)
    v_fma_f32 v68, v52, v116, v68
    v_fma_f32 v69, v53, v117, v69
    v_fma_f32 v70, v54, v118, v70
    v_fma_f32 v71, v55, v119, v71
    v_cvt_pk_bf16_f32 v190, v68, v69
    v_cvt_pk_bf16_f32 v191, v70, v71
    v_min_u32 v190, -2, v190
    s_cmp_lg_u32 s78, 0
    s_cbranch_scc1 DS1A
    buffer_store_dwordx4 v[188:191], v12, s[24:27], s32 offen
DS1B:
    v_add_u32 v12, 53248, v12
    s_waitcnt vmcnt(13)
    v_max3_u32 v15, v148, v150, v152
    v_max_u32 v15, v15, v154
    v_cmp_eq_u32 vcc, -1, v15
    s_cbranch_vccz C1_0_3K
C1_0_3R:
    buffer_load_dwordx4 v[148:151], v11, s[24:27], s35 offen sc1
    buffer_load_dwordx4 v[152:155], v11, s[24:27], s36 offen sc1
    s_sub_u32 s73, s73, 1
    s_cbranch_scc1 END
    s_waitcnt vmcnt(0)
    v_max3_u32 v15, v148, v150, v152
    v_max_u32 v15, v15, v154
    v_cmp_eq_u32 vcc, -1, v15
    s_cbranch_vccnz C1_0_3R
C1_0_3K:
    v_mfma_f32_32x32x16_bf16 v[88:103], a[132:135], v[148:151], v[88:103]
    s_cmp_lg_u32 s78, 0
    s_cbranch_scc1 PS3A
    buffer_store_dwordx4 v[248:251], v243, s[24:27], s32 offen
PS3B:
    v_add_u32 v243, 53248, v243
    ds_read_b64_tr_b16 a[188:189], v4 offset:20480
    ds_read_b64_tr_b16 a[190:191], v4 offset:20992
    v_mfma_f32_32x32x16_bf16 v[72:87], a[128:131], v[148:151], v[72:87]
    s_add_u32 m0, s71, 18432
    s_add_u32 s54, s54, 1384448
    buffer_load_dwordx4 v1, s[8:11], s54 offen lds
    ds_read_b64_tr_b16 a[184:185], v3 offset:20480
    ds_read_b64_tr_b16 a[186:187], v3 offset:20992
    v_mfma_f32_32x32x16_bf16 v[88:103], a[140:143], v[152:155], v[88:103]
    buffer_load_dwordx4 v2, s[8:11], s54 offen offset:1024 lds
    ds_read_b64_tr_b16 a[196:197], v4 offset:22528
    v_mfma_f32_32x32x16_bf16 v[72:87], a[136:139], v[152:155], v[72:87]
    s_add_u32 m0, s71, 8192
    s_add_u32 s49, s49, 1384448
    buffer_load_dwordx4 v1, s[8:11], s49 offen lds
    ds_read_b64_tr_b16 a[198:199], v4 offset:23040
    ds_read_b64_tr_b16 a[192:193], v3 offset:22528
    s_waitcnt vmcnt(15)
    v_max3_u32 v15, v156, v158, v160
    v_max_u32 v15, v15, v162
    v_cmp_eq_u32 vcc, -1, v15
    s_cbranch_vccz C1_0_5K
C1_0_5R:
    buffer_load_dwordx4 v[156:159], v11, s[24:27], s37 offen sc1
    buffer_load_dwordx4 v[160:163], v11, s[24:27], s38 offen sc1
    s_sub_u32 s73, s73, 1
    s_cbranch_scc1 END
    s_waitcnt vmcnt(0)
    v_max3_u32 v15, v156, v158, v160
    v_max_u32 v15, v15, v162
    v_cmp_eq_u32 vcc, -1, v15
    s_cbranch_vccnz C1_0_5R
C1_0_5K:
    v_mfma_f32_32x32x16_bf16 v[88:103], a[148:151], v[156:159], v[88:103]
    ds_read_b64_tr_b16 a[194:195], v3 offset:23040
    v_mfma_f32_32x32x16_bf16 v[72:87], a[144:147], v[156:159], v[72:87]
    buffer_load_dwordx4 v2, s[8:11], s49 offen offset:1024 lds
    ds_read_b64_tr_b16 a[204:205], v4 offset:24576
    ds_read_b64_tr_b16 a[206:207], v4 offset:25088
    v_mfma_f32_32x32x16_bf16 v[88:103], a[156:159], v[160:163], v[88:103]
    s_add_u32 m0, s71, 10240
    s_add_u32 s50, s50, 1384448
    buffer_load_dwordx4 v1, s[8:11], s50 offen lds
    ds_read_b64_tr_b16 a[200:201], v3 offset:24576
    v_mfma_f32_32x32x16_bf16 v[72:87], a[152:155], v[160:163], v[72:87]
    buffer_load_dwordx4 v2, s[8:11], s50 offen offset:1024 lds
    ds_read_b64_tr_b16 a[202:203], v3 offset:25088
    ds_read_b64_tr_b16 a[4:5], v4 offset:0
    s_waitcnt vmcnt(16)
    v_max3_u32 v15, v164, v166, v168
    v_max_u32 v15, v15, v170
    v_cmp_eq_u32 vcc, -1, v15
    s_cbranch_vccz C1_0_7K
C1_0_7R:
    buffer_load_dwordx4 v[164:167], v11, s[24:27], s39 offen sc1
    buffer_load_dwordx4 v[168:171], v11, s[24:27], s40 offen sc1
    s_sub_u32 s73, s73, 1
    s_cbranch_scc1 END
    s_waitcnt vmcnt(0)
    v_max3_u32 v15, v164, v166, v168
    v_max_u32 v15, v15, v170
    v_cmp_eq_u32 vcc, -1, v15
    s_cbranch_vccnz C1_0_7R
C1_0_7K:
    v_mfma_f32_32x32x16_bf16 v[88:103], a[164:167], v[164:167], v[88:103]
    s_add_u32 m0, s71, 12288
    s_add_u32 s51, s51, 1384448
    buffer_load_dwordx4 v1, s[8:11], s51 offen lds
    ds_read_b64_tr_b16 a[6:7], v4 offset:512
    v_mfma_f32_32x32x16_bf16 v[72:87], a[160:163], v[164:167], v[72:87]
    ds_read_b64_tr_b16 a[0:1], v3 offset:0
    ds_read_b64_tr_b16 a[2:3], v3 offset:512
    v_mfma_f32_32x32x16_bf16 v[88:103], a[172:175], v[168:171], v[88:103]
    buffer_load_dwordx4 v2, s[8:11], s51 offen offset:1024 lds
    ds_read_b64_tr_b16 a[12:13], v4 offset:2048
    ds_read_b64_tr_b16 a[14:15], v4 offset:2560
    v_mfma_f32_32x32x16_bf16 v[72:87], a[168:171], v[168:171], v[72:87]
    buffer_load_dwordx4 v[192:195], v240, s[24:27], s33 offen sc1
    ds_read_b64_tr_b16 a[8:9], v3 offset:2048
    s_waitcnt vmcnt(17)
    v_max3_u32 v15, v172, v174, v176
    v_max_u32 v15, v15, v178
    v_cmp_eq_u32 vcc, -1, v15
    s_cbranch_vccz C1_0_9K
C1_0_9R:
    buffer_load_dwordx4 v[172:175], v11, s[24:27], s41 offen sc1
    buffer_load_dwordx4 v[176:179], v11, s[24:27], s42 offen sc1
    s_sub_u32 s73, s73, 1
    s_cbranch_scc1 END
    s_waitcnt vmcnt(0)
    v_max3_u32 v15, v172, v174, v176
    v_max_u32 v15, v15, v178
    v_cmp_eq_u32 vcc, -1, v15
    s_cbranch_vccnz C1_0_9R
C1_0_9K:
    v_mfma_f32_32x32x16_bf16 v[88:103], a[180:183], v[172:175], v[88:103]
    buffer_load_dwordx4 v[196:199], v240, s[24:27], s34 offen sc1
    ds_read_b64_tr_b16 a[10:11], v3 offset:2560
    ds_read_b64_tr_b16 a[20:21], v4 offset:4096
    v_mfma_f32_32x32x16_bf16 v[72:87], a[176:179], v[172:175], v[72:87]
    buffer_load_dwordx4 v[200:203], v240, s[24:27], s35 offen sc1
    ds_read_b64_tr_b16 a[22:23], v4 offset:4608
    s_waitcnt lgkmcnt(15)
    v_mfma_f32_32x32x16_bf16 v[88:103], a[188:191], v[176:179], v[88:103]
    ds_read_b64_tr_b16 a[16:17], v3 offset:4096
    ds_read_b64_tr_b16 a[18:19], v3 offset:4608
    s_waitcnt vmcnt(17)
    v_max3_u32 v15, v180, v182, v184
    v_max_u32 v15, v15, v186
    v_cmp_eq_u32 vcc, -1, v15
    s_cbranch_vccz C1_0_11K
C1_0_11R:
    buffer_load_dwordx4 v[180:183], v11, s[24:27], s43 offen sc1
    buffer_load_dwordx4 v[184:187], v11, s[24:27], s44 offen sc1
    s_sub_u32 s73, s73, 1
    s_cbranch_scc1 END
    s_waitcnt vmcnt(0)
    v_max3_u32 v15, v180, v182, v184
    v_max_u32 v15, v15, v186
    v_cmp_eq_u32 vcc, -1, v15
    s_cbranch_vccnz C1_0_11R
C1_0_11K:
    v_mfma_f32_32x32x16_bf16 v[88:103], a[196:199], v[180:183], v[88:103]
    buffer_load_dwordx4 v[204:207], v240, s[24:27], s36 offen sc1
    ds_read_b64_tr_b16 a[28:29], v4 offset:6144
    s_waitcnt lgkmcnt(15)
    v_mfma_f32_32x32x16_bf16 v[88:103], a[204:207], v[184:187], v[88:103]
    buffer_load_dwordx4 v[208:211], v240, s[24:27], s37 offen sc1
    ds_read_b64_tr_b16 a[30:31], v4 offset:6656
    ds_read_b64_tr_b16 a[24:25], v3 offset:6144
    v_mfma_f32_32x32x16_bf16 v[72:87], a[184:187], v[176:179], v[72:87]
    buffer_load_dwordx4 v[212:215], v240, s[24:27], s38 offen sc1
    ds_read_b64_tr_b16 a[26:27], v3 offset:6656
    v_add_u32 v11, 106496, v11
    v_mfma_f32_32x32x16_bf16 v[72:87], a[192:195], v[180:183], v[72:87]
    s_nop 3
    ds_write_b128 v8, v[88:91] offset:8192
    ds_write_b128 v8, v[92:95] offset:9216
    buffer_load_dwordx4 v[216:219], v240, s[24:27], s39 offen sc1
    s_waitcnt lgkmcnt(15)
    v_mfma_f32_32x32x16_bf16 v[72:87], a[200:203], v[184:187], v[72:87]
    ds_write_b128 v9, v[96:99] offset:16384
    ds_write_b128 v9, v[100:103] offset:17408
    v_mfma_f32_32x32x16_bf16 v[120:135], a[108:111], v[188:191], 0
    buffer_load_dwordx4 v[220:223], v240, s[24:27], s40 offen sc1
    buffer_load_dwordx4 v[224:227], v240, s[24:27], s41 offen sc1
    v_mfma_f32_32x32x16_bf16 v[104:119], a[104:107], v[188:191], v[24:39]
    s_nop 5
    ds_write_b128 v7, v[80:83] offset:0
    ds_write_b128 v7, v[84:87] offset:1024
    buffer_load_dwordx4 v[228:231], v240, s[24:27], s42 offen sc1
    buffer_load_dwordx4 v[232:235], v240, s[24:27], s43 offen sc1
    s_waitcnt vmcnt(9)
    v_max3_u32 v15, v192, v194, v196
    v_max_u32 v15, v15, v198
    v_cmp_eq_u32 vcc, -1, v15
    v_fma_f32 v56, v40, v72, v56
    v_fma_f32 v57, v41, v73, v57
    v_fma_f32 v58, v42, v74, v58
    v_fma_f32 v59, v43, v75, v59
    v_fma_f32 v60, v44, v76, v60
    v_fma_f32 v61, v45, v77, v61
    v_fma_f32 v62, v46, v78, v62
    v_fma_f32 v63, v47, v79, v63
    s_cbranch_vccz C1_1_1K
C1_1_1R:
    buffer_load_dwordx4 v[192:195], v240, s[24:27], s33 offen sc1
    buffer_load_dwordx4 v[196:199], v240, s[24:27], s34 offen sc1
    s_sub_u32 s73, s73, 1
    s_cbranch_scc1 END
    s_waitcnt vmcnt(0)
    v_max3_u32 v15, v192, v194, v196
    v_max_u32 v15, v15, v198
    v_cmp_eq_u32 vcc, -1, v15
    s_cbranch_vccnz C1_1_1R
C1_1_1K:
    v_mfma_f32_32x32x16_bf16 v[120:135], a[116:119], v[192:195], v[120:135]
    buffer_load_dwordx4 v[236:239], v240, s[24:27], s44 offen sc1
    s_add_u32 m0, s71, 20480
    s_add_u32 s55, s55, 1384448
    buffer_load_dwordx4 v1, s[8:11], s55 offen lds
    s_waitcnt lgkmcnt(0)
    s_barrier
    ds_read_b128 v[88:91], v10 offset:8192
    ds_read_b128 v[96:99], v10 offset:16384
    ds_read_b128 v[80:83], v10 offset:0
    v_mfma_f32_32x32x16_bf16 v[104:119], a[112:115], v[192:195], v[104:119]
    ds_read_b128 v[92:95], v10 offset:9216
    ds_read_b128 v[100:103], v10 offset:17408
    ds_read_b128 v[84:87], v10 offset:1024
    buffer_load_dwordx4 v2, s[8:11], s55 offen offset:1024 lds
    s_add_u32 m0, s71, 22528
    s_add_u32 s56, s56, 1384448
    buffer_load_dwordx4 v1, s[8:11], s56 offen lds
    v_mfma_f32_32x32x16_bf16 v[120:135], a[124:127], v[196:199], v[120:135]
    s_waitcnt lgkmcnt(5)
    v_fma_f32 v56, v40, v88, v56
    v_fma_f32 v57, v41, v89, v57
    v_fma_f32 v58, v42, v90, v58
    v_fma_f32 v59, v43, v91, v59
    s_waitcnt lgkmcnt(4)
    v_fma_f32 v56, v40, v96, v56
    v_fma_f32 v57, v41, v97, v57
    v_fma_f32 v58, v42, v98, v58
    v_fma_f32 v59, v43, v99, v59
    s_waitcnt lgkmcnt(3)
    v_fma_f32 v56, v40, v80, v56
    v_fma_f32 v57, v41, v81, v57
    v_fma_f32 v58, v42, v82, v58
    v_fma_f32 v59, v43, v83, v59
    v_cvt_pk_bf16_f32 v136, v56, v57
    v_cvt_pk_bf16_f32 v137, v58, v59
    v_min_u32 v136, -2, v136
    buffer_load_dwordx4 v2, s[8:11], s56 offen offset:1024 lds
    v_mfma_f32_32x32x16_bf16 v[104:119], a[120:123], v[196:199], v[104:119]
    s_waitcnt lgkmcnt(2)
    v_fma_f32 v60, v44, v92, v60
    v_fma_f32 v61, v45, v93, v61
    v_fma_f32 v62, v46, v94, v62
    v_fma_f32 v63, v47, v95, v63
    s_waitcnt lgkmcnt(1)
    v_fma_f32 v60, v44, v100, v60
    v_fma_f32 v61, v45, v101, v61
    v_fma_f32 v62, v46, v102, v62
    v_fma_f32 v63, v47, v103, v63
    s_waitcnt lgkmcnt(0)
    v_fma_f32 v60, v44, v84, v60
    v_fma_f32 v61, v45, v85, v61
    v_fma_f32 v62, v46, v86, v62
    v_fma_f32 v63, v47, v87, v63
    v_cvt_pk_bf16_f32 v138, v60, v61
    v_cvt_pk_bf16_f32 v139, v62, v63
    v_min_u32 v138, -2, v138
    s_cmp_lg_u32 s78, 0
    s_cbranch_scc1 DS2A
    buffer_store_dwordx4 v[136:139], v12, s[24:27], s32 offen
DS2B:
    v_add_u32 v12, 53248, v12
    s_waitcnt vmcnt(13)
    v_max3_u32 v15, v200, v202, v204
    v_max_u32 v15, v15, v206
    v_cmp_eq_u32 vcc, -1, v15
    s_cbranch_vccz C1_1_3K
C1_1_3R:
    buffer_load_dwordx4 v[200:203], v240, s[24:27], s35 offen sc1
    buffer_load_dwordx4 v[204:207], v240, s[24:27], s36 offen sc1
    s_sub_u32 s73, s73, 1
    s_cbranch_scc1 END
    s_waitcnt vmcnt(0)
    v_max3_u32 v15, v200, v202, v204
    v_max_u32 v15, v15, v206
    v_cmp_eq_u32 vcc, -1, v15
    s_cbranch_vccnz C1_1_3R
C1_1_3K:
    v_mfma_f32_32x32x16_bf16 v[120:135], a[132:135], v[200:203], v[120:135]
    s_cmp_lg_u32 s78, 0
    s_cbranch_scc1 PS4A
    buffer_store_dwordx4 v[248:251], v243, s[24:27], s32 offen
PS4B:
    v_subrev_u32 v243, 212992, v243
    ds_read_b64_tr_b16 a[60:61], v4 offset:14336
    ds_read_b64_tr_b16 a[62:63], v4 offset:14848
    v_mfma_f32_32x32x16_bf16 v[104:119], a[128:131], v[200:203], v[104:119]
    s_add_u32 m0, s71, 24576
    s_add_u32 s57, s57, 1384448
    buffer_load_dwordx4 v1, s[8:11], s57 offen lds
    ds_read_b64_tr_b16 a[56:57], v3 offset:14336
    v_mfma_f32_32x32x16_bf16 v[120:135], a[140:143], v[204:207], v[120:135]
    buffer_load_dwordx4 v2, s[8:11], s57 offen offset:1024 lds
    ds_read_b64_tr_b16 a[58:59], v3 offset:14848
    v_mfma_f32_32x32x16_bf16 v[104:119], a[136:139], v[204:207], v[104:119]
    s_add_u32 m0, s71, 2048
    s_add_u32 s46, s46, 1384448
    buffer_load_dwordx4 v1, s[8:11], s46 offen lds
    ds_read_b64_tr_b16 a[68:69], v4 offset:16384
    ds_read_b64_tr_b16 a[70:71], v4 offset:16896
    s_waitcnt vmcnt(15)
    v_max3_u32 v15, v208, v210, v212
    v_max_u32 v15, v15, v214
    v_cmp_eq_u32 vcc, -1, v15
    s_cbranch_vccz C1_1_5K
C1_1_5R:
    buffer_load_dwordx4 v[208:211], v240, s[24:27], s37 offen sc1
    buffer_load_dwordx4 v[212:215], v240, s[24:27], s38 offen sc1
    s_sub_u32 s73, s73, 1
    s_cbranch_scc1 END
    s_waitcnt vmcnt(0)
    v_max3_u32 v15, v208, v210, v212
    v_max_u32 v15, v15, v214
    v_cmp_eq_u32 vcc, -1, v15
    s_cbranch_vccnz C1_1_5R
C1_1_5K:
    v_mfma_f32_32x32x16_bf16 v[120:135], a[148:151], v[208:211], v[120:135]
    buffer_load_dwordx4 v2, s[8:11], s46 offen offset:1024 lds
    ds_read_b64_tr_b16 a[64:65], v3 offset:16384
    v_mfma_f32_32x32x16_bf16 v[104:119], a[144:147], v[208:211], v[104:119]
    s_add_u32 m0, s71, 4096
    s_add_u32 s47, s47, 1384448
    buffer_load_dwordx4 v1, s[8:11], s47 offen lds
    ds_read_b64_tr_b16 a[66:67], v3 offset:16896
    v_mfma_f32_32x32x16_bf16 v[120:135], a[156:159], v[212:215], v[120:135]
    buffer_load_dwordx4 v2, s[8:11], s47 offen offset:1024 lds
    ds_read_b64_tr_b16 a[76:77], v4 offset:18432
    ds_read_b64_tr_b16 a[78:79], v4 offset:18944
    v_mfma_f32_32x32x16_bf16 v[104:119], a[152:155], v[212:215], v[104:119]
    s_add_u32 m0, s71, 6144
    s_add_u32 s48, s48, 1384448
    buffer_load_dwordx4 v1, s[8:11], s48 offen lds
    ds_read_b64_tr_b16 a[72:73], v3 offset:18432
    s_waitcnt vmcnt(17)
    v_max3_u32 v15, v216, v218, v220
    v_max_u32 v15, v15, v222
    v_cmp_eq_u32 vcc, -1, v15
    s_cbranch_vccz C1_1_7K
C1_1_7R:
    buffer_load_dwordx4 v[216:219], v240, s[24:27], s39 offen sc1
    buffer_load_dwordx4 v[220:223], v240, s[24:27], s40 offen sc1
    s_sub_u32 s73, s73, 1
    s_cbranch_scc1 END
    s_waitcnt vmcnt(0)
    v_max3_u32 v15, v216, v218, v220
    v_max_u32 v15, v15, v222
    v_cmp_eq_u32 vcc, -1, v15
    s_cbranch_vccnz C1_1_7R
C1_1_7K:
    v_mfma_f32_32x32x16_bf16 v[120:135], a[164:167], v[216:219], v[120:135]
    buffer_load_dwordx4 v2, s[8:11], s48 offen offset:1024 lds
    ds_read_b64_tr_b16 a[74:75], v3 offset:18944
    ds_read_b128 v[16:19], v14 offset:64
    v_mfma_f32_32x32x16_bf16 v[104:119], a[160:163], v[216:219], v[104:119]
    ds_read_b64_tr_b16 a[36:37], v4 offset:8192
    ds_read_b64_tr_b16 a[38:39], v4 offset:8704
    v_mfma_f32_32x32x16_bf16 v[120:135], a[172:175], v[220:223], v[120:135]
    s_add_u32 m0, s71, 0
    s_add_u32 s45, s45, 1384448
    buffer_load_dwordx4 v1, s[8:11], s45 offen lds
    ds_read_b64_tr_b16 a[32:33], v3 offset:8192
    v_mfma_f32_32x32x16_bf16 v[104:119], a[168:171], v[220:223], v[104:119]
    buffer_load_dwordx4 v2, s[8:11], s45 offen offset:1024 lds
    ds_read_b64_tr_b16 a[34:35], v3 offset:8704
    s_waitcnt vmcnt(18)
    v_max3_u32 v15, v224, v226, v228
    v_max_u32 v15, v15, v230
    v_cmp_eq_u32 vcc, -1, v15
    s_cbranch_vccz C1_1_9K
C1_1_9R:
    buffer_load_dwordx4 v[224:227], v240, s[24:27], s41 offen sc1
    buffer_load_dwordx4 v[228:231], v240, s[24:27], s42 offen sc1
    s_sub_u32 s73, s73, 1
    s_cbranch_scc1 END
    s_waitcnt vmcnt(0)
    v_max3_u32 v15, v224, v226, v228
    v_max_u32 v15, v15, v230
    v_cmp_eq_u32 vcc, -1, v15
    s_cbranch_vccnz C1_1_9R
C1_1_9K:
    v_mfma_f32_32x32x16_bf16 v[120:135], a[180:183], v[224:227], v[120:135]
    buffer_load_dwordx4 v[140:143], v11, s[24:27], s33 offen sc1
    ds_read_b64_tr_b16 a[44:45], v4 offset:10240
    ds_read_b64_tr_b16 a[46:47], v4 offset:10752
    v_mfma_f32_32x32x16_bf16 v[104:119], a[176:179], v[224:227], v[104:119]
    buffer_load_dwordx4 v[144:147], v11, s[24:27], s34 offen sc1
    ds_read_b64_tr_b16 a[40:41], v3 offset:10240
    v_mfma_f32_32x32x16_bf16 v[120:135], a[188:191], v[228:231], v[120:135]
    buffer_load_dwordx4 v[148:151], v11, s[24:27], s35 offen sc1
    ds_read_b64_tr_b16 a[42:43], v3 offset:10752
    s_waitcnt vmcnt(19)
    v_max3_u32 v15, v232, v234, v236
    v_max_u32 v15, v15, v238
    v_cmp_eq_u32 vcc, -1, v15
    s_cbranch_vccz C1_1_11K
C1_1_11R:
    buffer_load_dwordx4 v[232:235], v240, s[24:27], s43 offen sc1
    buffer_load_dwordx4 v[236:239], v240, s[24:27], s44 offen sc1
    s_sub_u32 s73, s73, 1
    s_cbranch_scc1 END
    s_waitcnt vmcnt(0)
    v_max3_u32 v15, v232, v234, v236
    v_max_u32 v15, v15, v238
    v_cmp_eq_u32 vcc, -1, v15
    s_cbranch_vccnz C1_1_11R
C1_1_11K:
    v_mfma_f32_32x32x16_bf16 v[120:135], a[196:199], v[232:235], v[120:135]
    buffer_load_dwordx4 v[152:155], v11, s[24:27], s36 offen sc1
    ds_read_b64_tr_b16 a[52:53], v4 offset:12288
    ds_read_b64_tr_b16 a[54:55], v4 offset:12800
    s_waitcnt lgkmcnt(10)
    v_lshlrev_b32 v24, 16, v16
    v_and_b32 v25, 0xffff0000, v16
    v_mfma_f32_32x32x16_bf16 v[120:135], a[204:207], v[236:239], v[120:135]
    buffer_load_dwordx4 v[156:159], v11, s[24:27], s37 offen sc1
    ds_read_b64_tr_b16 a[48:49], v3 offset:12288
    v_lshlrev_b32 v26, 16, v17
    v_and_b32 v27, 0xffff0000, v17
    v_lshlrev_b32 v28, 16, v18
    v_mfma_f32_32x32x16_bf16 v[104:119], a[184:187], v[228:231], v[104:119]
    buffer_load_dwordx4 v[160:163], v11, s[24:27], s38 offen sc1
    ds_read_b64_tr_b16 a[50:51], v3 offset:12800
    v_add_u32 v240, 106496, v240
    v_and_b32 v29, 0xffff0000, v18
    v_lshlrev_b32 v30, 16, v19
    v_and_b32 v31, 0xffff0000, v19
    v_mfma_f32_32x32x16_bf16 v[104:119], a[192:195], v[232:235], v[104:119]
    ds_write_b128 v8, v[120:123] offset:32768
    ds_write_b128 v8, v[124:127] offset:33792
    buffer_load_dwordx4 v[164:167], v11, s[24:27], s39 offen sc1
    v_mfma_f32_32x32x16_bf16 v[104:119], a[200:203], v[236:239], v[104:119]
    ds_write_b128 v9, v[128:131] offset:40960
    ds_write_b128 v9, v[132:135] offset:41984
    v_mfma_f32_32x32x16_bf16 v[88:103], a[4:7], v[136:139], 0
    buffer_load_dwordx4 v[168:171], v11, s[24:27], s40 offen sc1
    buffer_load_dwordx4 v[172:175], v11, s[24:27], s41 offen sc1
    v_mfma_f32_32x32x16_bf16 v[72:87], a[0:3], v[136:139], v[24:39]
    s_nop 5
    ds_write_b128 v7, v[112:115] offset:24576
    ds_write_b128 v7, v[116:119] offset:25600
    buffer_load_dwordx4 v[176:179], v11, s[24:27], s42 offen sc1
    buffer_load_dwordx4 v[180:183], v11, s[24:27], s43 offen sc1
    s_waitcnt vmcnt(9)
    v_max3_u32 v15, v140, v142, v144
    v_max_u32 v15, v15, v146
    v_cmp_eq_u32 vcc, -1, v15
    v_fma_f32 v64, v48, v104, v64
    v_fma_f32 v65, v49, v105, v65
    v_fma_f32 v66, v50, v106, v66
    v_fma_f32 v67, v51, v107, v67
    v_fma_f32 v68, v52, v108, v68
    v_fma_f32 v69, v53, v109, v69
    v_fma_f32 v70, v54, v110, v70
    v_fma_f32 v71, v55, v111, v71
    s_cbranch_vccz C2_0_1K
C2_0_1R:
    buffer_load_dwordx4 v[140:143], v11, s[24:27], s33 offen sc1
    buffer_load_dwordx4 v[144:147], v11, s[24:27], s34 offen sc1
    s_sub_u32 s73, s73, 1
    s_cbranch_scc1 END
    s_waitcnt vmcnt(0)
    v_max3_u32 v15, v140, v142, v144
    v_max_u32 v15, v15, v146
    v_cmp_eq_u32 vcc, -1, v15
    s_cbranch_vccnz C2_0_1R
C2_0_1K:
    v_mfma_f32_32x32x16_bf16 v[88:103], a[12:15], v[140:143], v[88:103]
    buffer_load_dwordx4 v[184:187], v11, s[24:27], s44 offen sc1
    s_add_u32 m0, s71, 14336
    s_add_u32 s52, s52, 1384448
    buffer_load_dwordx4 v1, s[8:11], s52 offen lds
    s_waitcnt lgkmcnt(0)
    s_barrier
    ds_read_b128 v[120:123], v10 offset:32768
    ds_read_b128 v[128:131], v10 offset:40960
    ds_read_b128 v[112:115], v10 offset:24576
    v_mfma_f32_32x32x16_bf16 v[72:87], a[8:11], v[140:143], v[72:87]
    ds_read_b128 v[124:127], v10 offset:33792
    ds_read_b128 v[132:135], v10 offset:41984
    ds_read_b128 v[116:119], v10 offset:25600
    buffer_load_dwordx4 v2, s[8:11], s52 offen offset:1024 lds
    s_add_u32 m0, s71, 16384
    s_add_u32 s53, s53, 1384448
    buffer_load_dwordx4 v1, s[8:11], s53 offen lds
    v_mfma_f32_32x32x16_bf16 v[88:103], a[20:23], v[144:147], v[88:103]
    s_waitcnt lgkmcnt(5)
    v_fma_f32 v64, v48, v120, v64
    v_fma_f32 v65, v49, v121, v65
    v_fma_f32 v66, v50, v122, v66
    v_fma_f32 v67, v51, v123, v67
    s_waitcnt lgkmcnt(4)
    v_fma_f32 v64, v48, v128, v64
    v_fma_f32 v65, v49, v129, v65
    v_fma_f32 v66, v50, v130, v66
    v_fma_f32 v67, v51, v131, v67
    s_waitcnt lgkmcnt(3)
    v_fma_f32 v64, v48, v112, v64
    v_fma_f32 v65, v49, v113, v65
    v_fma_f32 v66, v50, v114, v66
    v_fma_f32 v67, v51, v115, v67
    v_cvt_pk_bf16_f32 v188, v64, v65
    v_cvt_pk_bf16_f32 v189, v66, v67
    v_min_u32 v188, -2, v188
    buffer_load_dwordx4 v2, s[8:11], s53 offen offset:1024 lds
    v_mfma_f32_32x32x16_bf16 v[72:87], a[16:19], v[144:147], v[72:87]
    s_waitcnt lgkmcnt(2)
    v_fma_f32 v68, v52, v124, v68
    v_fma_f32 v69, v53, v125, v69
    v_fma_f32 v70, v54, v126, v70
    v_fma_f32 v71, v55, v127, v71
    s_waitcnt lgkmcnt(1)
    v_fma_f32 v68, v52, v132, v68
    v_fma_f32 v69, v53, v133, v69
    v_fma_f32 v70, v54, v134, v70
    v_fma_f32 v71, v55, v135, v71
    s_waitcnt lgkmcnt(0)
    v_fma_f32 v68, v52, v116, v68
    v_fma_f32 v69, v53, v117, v69
    v_fma_f32 v70, v54, v118, v70
    v_fma_f32 v71, v55, v119, v71
    v_cvt_pk_bf16_f32 v190, v68, v69
    v_cvt_pk_bf16_f32 v191, v70, v71
    v_min_u32 v190, -2, v190
    s_cmp_lg_u32 s78, 0
    s_cbranch_scc1 DS3A
    buffer_store_dwordx4 v[188:191], v12, s[24:27], s32 offen
DS3B:
    v_add_u32 v12, 53248, v12
    s_waitcnt vmcnt(13)
    v_max3_u32 v15, v148, v150, v152
    v_max_u32 v15, v15, v154
    v_cmp_eq_u32 vcc, -1, v15
    s_cbranch_vccz C2_0_3K
C2_0_3R:
    buffer_load_dwordx4 v[148:151], v11, s[24:27], s35 offen sc1
    buffer_load_dwordx4 v[152:155], v11, s[24:27], s36 offen sc1
    s_sub_u32 s73, s73, 1
    s_cbranch_scc1 END
    s_waitcnt vmcnt(0)
    v_max3_u32 v15, v148, v150, v152
    v_max_u32 v15, v15, v154
    v_cmp_eq_u32 vcc, -1, v15
    s_cbranch_vccnz C2_0_3R
C2_0_3K:
    v_mfma_f32_32x32x16_bf16 v[88:103], a[28:31], v[148:151], v[88:103]
    s_add_u32 m0, s71, 18432
    s_add_u32 s54, s54, 1384448
    buffer_load_dwordx4 v1, s[8:11], s54 offen lds
    ds_read_b64_tr_b16 a[84:85], v4 offset:20480
    ds_read_b64_tr_b16 a[86:87], v4 offset:20992
    v_mfma_f32_32x32x16_bf16 v[72:87], a[24:27], v[148:151], v[72:87]
    buffer_load_dwordx4 v2, s[8:11], s54 offen offset:1024 lds
    ds_read_b64_tr_b16 a[80:81], v3 offset:20480
    ds_read_b64_tr_b16 a[82:83], v3 offset:20992
    v_mfma_f32_32x32x16_bf16 v[88:103], a[36:39], v[152:155], v[88:103]
    s_add_u32 m0, s71, 8192
    s_add_u32 s49, s49, 1384448
    buffer_load_dwordx4 v1, s[8:11], s49 offen lds
    ds_read_b64_tr_b16 a[92:93], v4 offset:22528
    v_mfma_f32_32x32x16_bf16 v[72:87], a[32:35], v[152:155], v[72:87]
    ds_read_b64_tr_b16 a[94:95], v4 offset:23040
    ds_read_b64_tr_b16 a[88:89], v3 offset:22528
    s_waitcnt vmcnt(14)
    v_max3_u32 v15, v156, v158, v160
    v_max_u32 v15, v15, v162
    v_cmp_eq_u32 vcc, -1, v15
    s_cbranch_vccz C2_0_5K
C2_0_5R:
    buffer_load_dwordx4 v[156:159], v11, s[24:27], s37 offen sc1
    buffer_load_dwordx4 v[160:163], v11, s[24:27], s38 offen sc1
    s_sub_u32 s73, s73, 1
    s_cbranch_scc1 END
    s_waitcnt vmcnt(0)
    v_max3_u32 v15, v156, v158, v160
    v_max_u32 v15, v15, v162
    v_cmp_eq_u32 vcc, -1, v15
    s_cbranch_vccnz C2_0_5R
C2_0_5K:
    v_mfma_f32_32x32x16_bf16 v[88:103], a[44:47], v[156:159], v[88:103]
    buffer_load_dwordx4 v2, s[8:11], s49 offen offset:1024 lds
    ds_read_b64_tr_b16 a[90:91], v3 offset:23040
    v_mfma_f32_32x32x16_bf16 v[72:87], a[40:43], v[156:159], v[72:87]
    s_add_u32 m0, s71, 10240
    s_add_u32 s50, s50, 1384448
    buffer_load_dwordx4 v1, s[8:11], s50 offen lds
    ds_read_b64_tr_b16 a[100:101], v4 offset:24576
    ds_read_b64_tr_b16 a[102:103], v4 offset:25088
    v_mfma_f32_32x32x16_bf16 v[88:103], a[52:55], v[160:163], v[88:103]
    buffer_load_dwordx4 v2, s[8:11], s50 offen offset:1024 lds
    ds_read_b64_tr_b16 a[96:97], v3 offset:24576
    v_mfma_f32_32x32x16_bf16 v[72:87], a[48:51], v[160:163], v[72:87]
    ds_read_b64_tr_b16 a[98:99], v3 offset:25088
    ds_read_b64_tr_b16 a[108:109], v4 offset:0
    s_waitcnt vmcnt(15)
    v_max3_u32 v15, v164, v166, v168
    v_max_u32 v15, v15, v170
    v_cmp_eq_u32 vcc, -1, v15
    s_cbranch_vccz C2_0_7K
C2_0_7R:
    buffer_load_dwordx4 v[164:167], v11, s[24:27], s39 offen sc1
    buffer_load_dwordx4 v[168:171], v11, s[24:27], s40 offen sc1
    s_sub_u32 s73, s73, 1
    s_cbranch_scc1 END
    s_waitcnt vmcnt(0)
    v_max3_u32 v15, v164, v166, v168
    v_max_u32 v15, v15, v170
    v_cmp_eq_u32 vcc, -1, v15
    s_cbranch_vccnz C2_0_7R
C2_0_7K:
    v_mfma_f32_32x32x16_bf16 v[88:103], a[60:63], v[164:167], v[88:103]
    s_add_u32 m0, s71, 12288
    s_add_u32 s51, s51, 1384448
    buffer_load_dwordx4 v1, s[8:11], s51 offen lds
    ds_read_b64_tr_b16 a[110:111], v4 offset:512
    v_mfma_f32_32x32x16_bf16 v[72:87], a[56:59], v[164:167], v[72:87]
    buffer_load_dwordx4 v2, s[8:11], s51 offen offset:1024 lds
    ds_read_b64_tr_b16 a[104:105], v3 offset:0
    ds_read_b64_tr_b16 a[106:107], v3 offset:512
    v_mfma_f32_32x32x16_bf16 v[88:103], a[68:71], v[168:171], v[88:103]
    buffer_load_dwordx4 v[192:195], v240, s[24:27], s33 offen sc1
    ds_read_b64_tr_b16 a[116:117], v4 offset:2048
    ds_read_b64_tr_b16 a[118:119], v4 offset:2560
    v_mfma_f32_32x32x16_bf16 v[72:87], a[64:67], v[168:171], v[72:87]
    ds_read_b64_tr_b16 a[112:113], v3 offset:2048
    s_waitcnt vmcnt(16)
    v_max3_u32 v15, v172, v174, v176
    v_max_u32 v15, v15, v178
    v_cmp_eq_u32 vcc, -1, v15
    s_cbranch_vccz C2_0_9K
C2_0_9R:
    buffer_load_dwordx4 v[172:175], v11, s[24:27], s41 offen sc1
    buffer_load_dwordx4 v[176:179], v11, s[24:27], s42 offen sc1
    s_sub_u32 s73, s73, 1
    s_cbranch_scc1 END
    s_waitcnt vmcnt(0)
    v_max3_u32 v15, v172, v174, v176
    v_max_u32 v15, v15, v178
    v_cmp_eq_u32 vcc, -1, v15
    s_cbranch_vccnz C2_0_9R
C2_0_9K:
    v_mfma_f32_32x32x16_bf16 v[88:103], a[76:79], v[172:175], v[88:103]
    buffer_load_dwordx4 v[196:199], v240, s[24:27], s34 offen sc1
    ds_read_b64_tr_b16 a[114:115], v3 offset:2560
    ds_read_b64_tr_b16 a[124:125], v4 offset:4096
    v_mfma_f32_32x32x16_bf16 v[72:87], a[72:75], v[172:175], v[72:87]
    buffer_load_dwordx4 v[200:203], v240, s[24:27], s35 offen sc1
    ds_read_b64_tr_b16 a[126:127], v4 offset:4608
    s_waitcnt lgkmcnt(15)
    v_mfma_f32_32x32x16_bf16 v[88:103], a[84:87], v[176:179], v[88:103]
    buffer_load_dwordx4 v[204:207], v240, s[24:27], s36 offen sc1
    ds_read_b64_tr_b16 a[120:121], v3 offset:4096
    ds_read_b64_tr_b16 a[122:123], v3 offset:4608
    s_waitcnt vmcnt(17)
    v_max3_u32 v15, v180, v182, v184
    v_max_u32 v15, v15, v186
    v_cmp_eq_u32 vcc, -1, v15
    s_cbranch_vccz C2_0_11K
C2_0_11R:
    buffer_load_dwordx4 v[180:183], v11, s[24:27], s43 offen sc1
    buffer_load_dwordx4 v[184:187], v11, s[24:27], s44 offen sc1
    s_sub_u32 s73, s73, 1
    s_cbranch_scc1 END
    s_waitcnt vmcnt(0)
    v_max3_u32 v15, v180, v182, v184
    v_max_u32 v15, v15, v186
    v_cmp_eq_u32 vcc, -1, v15
    s_cbranch_vccnz C2_0_11R
C2_0_11K:
    v_mfma_f32_32x32x16_bf16 v[88:103], a[92:95], v[180:183], v[88:103]
    ds_read_b64_tr_b16 a[132:133], v4 offset:6144
    s_waitcnt lgkmcnt(15)
    v_mfma_f32_32x32x16_bf16 v[88:103], a[100:103], v[184:187], v[88:103]
    s_cmp_lg_u32 s78, 0
    s_cbranch_scc1 PS5A
    buffer_store_dwordx4 v[248:251], v243, s[24:27], s32 offen
PS5B:
    v_add_u32 v243, 53248, v243
    buffer_load_dwordx4 v[208:211], v240, s[24:27], s37 offen sc1
    ds_read_b64_tr_b16 a[134:135], v4 offset:6656
    ds_read_b64_tr_b16 a[128:129], v3 offset:6144
    v_mfma_f32_32x32x16_bf16 v[72:87], a[80:83], v[176:179], v[72:87]
    buffer_load_dwordx4 v[212:215], v240, s[24:27], s38 offen sc1
    ds_read_b64_tr_b16 a[130:131], v3 offset:6656
    v_add_u32 v11, 106496, v11
    v_mfma_f32_32x32x16_bf16 v[72:87], a[88:91], v[180:183], v[72:87]
    ds_write_b128 v8, v[88:91] offset:8192
    ds_write_b128 v8, v[92:95] offset:9216
    buffer_load_dwordx4 v[216:219], v240, s[24:27], s39 offen sc1
    s_waitcnt lgkmcnt(15)
    v_mfma_f32_32x32x16_bf16 v[72:87], a[96:99], v[184:187], v[72:87]
    ds_write_b128 v9, v[96:99] offset:16384
    ds_write_b128 v9, v[100:103] offset:17408
    v_mfma_f32_32x32x16_bf16 v[120:135], a[4:7], v[188:191], 0
    buffer_load_dwordx4 v[220:223], v240, s[24:27], s40 offen sc1
    buffer_load_dwordx4 v[224:227], v240, s[24:27], s41 offen sc1
    v_mfma_f32_32x32x16_bf16 v[104:119], a[0:3], v[188:191], v[24:39]
    s_nop 5
    ds_write_b128 v7, v[80:83] offset:0
    ds_write_b128 v7, v[84:87] offset:1024
    buffer_load_dwordx4 v[228:231], v240, s[24:27], s42 offen sc1
    buffer_load_dwordx4 v[232:235], v240, s[24:27], s43 offen sc1
    s_waitcnt vmcnt(10)
    v_max3_u32 v15, v192, v194, v196
    v_max_u32 v15, v15, v198
    v_cmp_eq_u32 vcc, -1, v15
    v_fma_f32 v56, v40, v72, v56
    v_fma_f32 v57, v41, v73, v57
    v_fma_f32 v58, v42, v74, v58
    v_fma_f32 v59, v43, v75, v59
    v_fma_f32 v60, v44, v76, v60
    v_fma_f32 v61, v45, v77, v61
    v_fma_f32 v62, v46, v78, v62
    v_fma_f32 v63, v47, v79, v63
    s_cbranch_vccz C2_1_1K
C2_1_1R:
    buffer_load_dwordx4 v[192:195], v240, s[24:27], s33 offen sc1
    buffer_load_dwordx4 v[196:199], v240, s[24:27], s34 offen sc1
    s_sub_u32 s73, s73, 1
    s_cbranch_scc1 END
    s_waitcnt vmcnt(0)
    v_max3_u32 v15, v192, v194, v196
    v_max_u32 v15, v15, v198
    v_cmp_eq_u32 vcc, -1, v15
    s_cbranch_vccnz C2_1_1R
C2_1_1K:
    v_mfma_f32_32x32x16_bf16 v[120:135], a[12:15], v[192:195], v[120:135]
    buffer_load_dwordx4 v[236:239], v240, s[24:27], s44 offen sc1
    s_add_u32 m0, s71, 20480
    s_add_u32 s55, s55, 1384448
    buffer_load_dwordx4 v1, s[8:11], s55 offen lds
    s_waitcnt lgkmcnt(0)
    s_barrier
    ds_read_b128 v[88:91], v10 offset:8192
    ds_read_b128 v[96:99], v10 offset:16384
    ds_read_b128 v[80:83], v10 offset:0
    v_mfma_f32_32x32x16_bf16 v[104:119], a[8:11], v[192:195], v[104:119]
    ds_read_b128 v[92:95], v10 offset:9216
    ds_read_b128 v[100:103], v10 offset:17408
    ds_read_b128 v[84:87], v10 offset:1024
    buffer_load_dwordx4 v2, s[8:11], s55 offen offset:1024 lds
    s_add_u32 m0, s71, 22528
    s_add_u32 s56, s56, 1384448
    buffer_load_dwordx4 v1, s[8:11], s56 offen lds
    v_mfma_f32_32x32x16_bf16 v[120:135], a[20:23], v[196:199], v[120:135]
    s_waitcnt lgkmcnt(5)
    v_fma_f32 v56, v40, v88, v56
    v_fma_f32 v57, v41, v89, v57
    v_fma_f32 v58, v42, v90, v58
    v_fma_f32 v59, v43, v91, v59
    s_waitcnt lgkmcnt(4)
    v_fma_f32 v56, v40, v96, v56
    v_fma_f32 v57, v41, v97, v57
    v_fma_f32 v58, v42, v98, v58
    v_fma_f32 v59, v43, v99, v59
    s_waitcnt lgkmcnt(3)
    v_fma_f32 v56, v40, v80, v56
    v_fma_f32 v57, v41, v81, v57
    v_fma_f32 v58, v42, v82, v58
    v_fma_f32 v59, v43, v83, v59
    v_cvt_pk_bf16_f32 v136, v56, v57
    v_cvt_pk_bf16_f32 v137, v58, v59
    v_min_u32 v136, -2, v136
    buffer_load_dwordx4 v2, s[8:11], s56 offen offset:1024 lds
    v_mfma_f32_32x32x16_bf16 v[104:119], a[16:19], v[196:199], v[104:119]
    s_waitcnt lgkmcnt(2)
    v_fma_f32 v60, v44, v92, v60
    v_fma_f32 v61, v45, v93, v61
    v_fma_f32 v62, v46, v94, v62
    v_fma_f32 v63, v47, v95, v63
    s_waitcnt lgkmcnt(1)
    v_fma_f32 v60, v44, v100, v60
    v_fma_f32 v61, v45, v101, v61
    v_fma_f32 v62, v46, v102, v62
    v_fma_f32 v63, v47, v103, v63
    s_waitcnt lgkmcnt(0)
    v_fma_f32 v60, v44, v84, v60
    v_fma_f32 v61, v45, v85, v61
    v_fma_f32 v62, v46, v86, v62
    v_fma_f32 v63, v47, v87, v63
    v_cvt_pk_bf16_f32 v138, v60, v61
    v_cvt_pk_bf16_f32 v139, v62, v63
    v_min_u32 v138, -2, v138
    s_waitcnt vmcnt(12)
    s_cmp_lg_u32 s78, 0
    s_cbranch_scc1 DS4A
    buffer_store_dwordx4 v[136:139], v12, s[24:27], s32 offen
DS4B:
    v_subrev_u32 v12, 212992, v12
    v_max3_u32 v15, v200, v202, v204
    v_max_u32 v15, v15, v206
    v_cmp_eq_u32 vcc, -1, v15
    s_cbranch_vccz C2_1_3K
C2_1_3R:
    buffer_load_dwordx4 v[200:203], v240, s[24:27], s35 offen sc1
    buffer_load_dwordx4 v[204:207], v240, s[24:27], s36 offen sc1
    s_sub_u32 s73, s73, 1
    s_cbranch_scc1 END
    s_waitcnt vmcnt(0)
    v_max3_u32 v15, v200, v202, v204
    v_max_u32 v15, v15, v206
    v_cmp_eq_u32 vcc, -1, v15
    s_cbranch_vccnz C2_1_3R
C2_1_3K:
    v_mfma_f32_32x32x16_bf16 v[120:135], a[28:31], v[200:203], v[120:135]
    s_add_u32 m0, s71, 24576
    s_add_u32 s57, s57, 1384448
    buffer_load_dwordx4 v1, s[8:11], s57 offen lds
    ds_read_b64_tr_b16 a[164:165], v4 offset:14336
    ds_read_b64_tr_b16 a[166:167], v4 offset:14848
    v_mfma_f32_32x32x16_bf16 v[104:119], a[24:27], v[200:203], v[104:119]
    buffer_load_dwordx4 v2, s[8:11], s57 offen offset:1024 lds
    ds_read_b64_tr_b16 a[160:161], v3 offset:14336
    v_mfma_f32_32x32x16_bf16 v[120:135], a[36:39], v[204:207], v[120:135]
    s_add_u32 m0, s71, 2048
    s_add_u32 s46, s46, 1384448
    buffer_load_dwordx4 v1, s[8:11], s46 offen lds
    ds_read_b64_tr_b16 a[162:163], v3 offset:14848
    v_mfma_f32_32x32x16_bf16 v[104:119], a[32:35], v[204:207], v[104:119]
    buffer_load_dwordx4 v2, s[8:11], s46 offen offset:1024 lds
    ds_read_b64_tr_b16 a[172:173], v4 offset:16384
    ds_read_b64_tr_b16 a[174:175], v4 offset:16896
    s_waitcnt vmcnt(15)
    v_max3_u32 v15, v208, v210, v212
    v_max_u32 v15, v15, v214
    v_cmp_eq_u32 vcc, -1, v15
    s_cbranch_vccz C2_1_5K
C2_1_5R:
    buffer_load_dwordx4 v[208:211], v240, s[24:27], s37 offen sc1
    buffer_load_dwordx4 v[212:215], v240, s[24:27], s38 offen sc1
    s_sub_u32 s73, s73, 1
    s_cbranch_scc1 END
    s_waitcnt vmcnt(0)
    v_max3_u32 v15, v208, v210, v212
    v_max_u32 v15, v15, v214
    v_cmp_eq_u32 vcc, -1, v15
    s_cbranch_vccnz C2_1_5R
C2_1_5K:
    v_mfma_f32_32x32x16_bf16 v[120:135], a[44:47], v[208:211], v[120:135]
    s_add_u32 m0, s71, 4096
    s_add_u32 s47, s47, 1384448
    buffer_load_dwordx4 v1, s[8:11], s47 offen lds
    ds_read_b64_tr_b16 a[168:169], v3 offset:16384
    v_mfma_f32_32x32x16_bf16 v[104:119], a[40:43], v[208:211], v[104:119]
    buffer_load_dwordx4 v2, s[8:11], s47 offen offset:1024 lds
    ds_read_b64_tr_b16 a[170:171], v3 offset:16896
    v_mfma_f32_32x32x16_bf16 v[120:135], a[52:55], v[212:215], v[120:135]
    ds_read_b64_tr_b16 a[180:181], v4 offset:18432
    ds_read_b64_tr_b16 a[182:183], v4 offset:18944
    v_mfma_f32_32x32x16_bf16 v[104:119], a[48:51], v[212:215], v[104:119]
    s_add_u32 m0, s71, 6144
    s_add_u32 s48, s48, 1384448
    buffer_load_dwordx4 v1, s[8:11], s48 offen lds
    ds_read_b64_tr_b16 a[176:177], v3 offset:18432
    s_waitcnt vmcnt(16)
    v_max3_u32 v15, v216, v218, v220
    v_max_u32 v15, v15, v222
    v_cmp_eq_u32 vcc, -1, v15
    s_cbranch_vccz C2_1_7K
C2_1_7R:
    buffer_load_dwordx4 v[216:219], v240, s[24:27], s39 offen sc1
    buffer_load_dwordx4 v[220:223], v240, s[24:27], s40 offen sc1
    s_sub_u32 s73, s73, 1
    s_cbranch_scc1 END
    s_waitcnt vmcnt(0)
    v_max3_u32 v15, v216, v218, v220
    v_max_u32 v15, v15, v222
    v_cmp_eq_u32 vcc, -1, v15
    s_cbranch_vccnz C2_1_7R
C2_1_7K:
    v_mfma_f32_32x32x16_bf16 v[120:135], a[60:63], v[216:219], v[120:135]
    buffer_load_dwordx4 v2, s[8:11], s48 offen offset:1024 lds
    ds_read_b64_tr_b16 a[178:179], v3 offset:18944
    ds_read_b128 v[16:19], v14 offset:96
    v_mfma_f32_32x32x16_bf16 v[104:119], a[56:59], v[216:219], v[104:119]
    s_add_u32 m0, s71, 0
    s_add_u32 s45, s45, 1384448
    buffer_load_dwordx4 v1, s[8:11], s45 offen lds
    ds_read_b64_tr_b16 a[140:141], v4 offset:8192
    ds_read_b64_tr_b16 a[142:143], v4 offset:8704
    v_mfma_f32_32x32x16_bf16 v[120:135], a[68:71], v[220:223], v[120:135]
    buffer_load_dwordx4 v2, s[8:11], s45 offen offset:1024 lds
    ds_read_b64_tr_b16 a[136:137], v3 offset:8192
    v_mfma_f32_32x32x16_bf16 v[104:119], a[64:67], v[220:223], v[104:119]
    buffer_load_dwordx4 v[140:143], v11, s[24:27], s33 offen sc1
    ds_read_b64_tr_b16 a[138:139], v3 offset:8704
    s_waitcnt vmcnt(18)
    v_max3_u32 v15, v224, v226, v228
    v_max_u32 v15, v15, v230
    v_cmp_eq_u32 vcc, -1, v15
    s_cbranch_vccz C2_1_9K
C2_1_9R:
    buffer_load_dwordx4 v[224:227], v240, s[24:27], s41 offen sc1
    buffer_load_dwordx4 v[228:231], v240, s[24:27], s42 offen sc1
    s_sub_u32 s73, s73, 1
    s_cbranch_scc1 END
    s_waitcnt vmcnt(0)
    v_max3_u32 v15, v224, v226, v228
    v_max_u32 v15, v15, v230
    v_cmp_eq_u32 vcc, -1, v15
    s_cbranch_vccnz C2_1_9R
C2_1_9K:
    v_mfma_f32_32x32x16_bf16 v[120:135], a[76:79], v[224:227], v[120:135]
    buffer_load_dwordx4 v[144:147], v11, s[24:27], s34 offen sc1
    ds_read_b64_tr_b16 a[148:149], v4 offset:10240
    ds_read_b64_tr_b16 a[150:151], v4 offset:10752
    v_mfma_f32_32x32x16_bf16 v[104:119], a[72:75], v[224:227], v[104:119]
    ds_read_b64_tr_b16 a[144:145], v3 offset:10240
    v_mfma_f32_32x32x16_bf16 v[120:135], a[84:87], v[228:231], v[120:135]
    buffer_load_dwordx4 v[148:151], v11, s[24:27], s35 offen sc1
    ds_read_b64_tr_b16 a[146:147], v3 offset:10752
    s_waitcnt vmcnt(18)
    v_max3_u32 v15, v232, v234, v236
    v_max_u32 v15, v15, v238
    v_cmp_eq_u32 vcc, -1, v15
    s_cbranch_vccz C2_1_11K
C2_1_11R:
    buffer_load_dwordx4 v[232:235], v240, s[24:27], s43 offen sc1
    buffer_load_dwordx4 v[236:239], v240, s[24:27], s44 offen sc1
    s_sub_u32 s73, s73, 1
    s_cbranch_scc1 END
    s_waitcnt vmcnt(0)
    v_max3_u32 v15, v232, v234, v236
    v_max_u32 v15, v15, v238
    v_cmp_eq_u32 vcc, -1, v15
    s_cbranch_vccnz C2_1_11R
C2_1_11K:
    v_mfma_f32_32x32x16_bf16 v[120:135], a[92:95], v[232:235], v[120:135]
    buffer_load_dwordx4 v[152:155], v11, s[24:27], s36 offen sc1
    ds_read_b64_tr_b16 a[156:157], v4 offset:12288
    ds_read_b64_tr_b16 a[158:159], v4 offset:12800
    s_waitcnt lgkmcnt(10)
    v_lshlrev_b32 v24, 16, v16
    v_and_b32 v25, 0xffff0000, v16
    v_mfma_f32_32x32x16_bf16 v[120:135], a[100:103], v[236:239], v[120:135]
    s_cmp_lg_u32 s78, 0
    s_cbranch_scc1 PS6A
    buffer_store_dwordx4 v[248:251], v243, s[24:27], s32 offen
PS6B:
    v_add_u32 v243, 53248, v243
    buffer_load_dwordx4 v[156:159], v11, s[24:27], s37 offen sc1
    ds_read_b64_tr_b16 a[152:153], v3 offset:12288
    v_lshlrev_b32 v26, 16, v17
    v_and_b32 v27, 0xffff0000, v17
    v_lshlrev_b32 v28, 16, v18
    v_mfma_f32_32x32x16_bf16 v[104:119], a[80:83], v[228:231], v[104:119]
    buffer_load_dwordx4 v[160:163], v11, s[24:27], s38 offen sc1
    ds_read_b64_tr_b16 a[154:155], v3 offset:12800
    v_subrev_u32 v240, 159744, v240
    v_and_b32 v29, 0xffff0000, v18
    v_lshlrev_b32 v30, 16, v19
    v_and_b32 v31, 0xffff0000, v19
    v_mfma_f32_32x32x16_bf16 v[104:119], a[88:91], v[232:235], v[104:119]
    ds_write_b128 v8, v[120:123] offset:32768
    ds_write_b128 v8, v[124:127] offset:33792
    buffer_load_dwordx4 v[164:167], v11, s[24:27], s39 offen sc1
    v_mfma_f32_32x32x16_bf16 v[104:119], a[96:99], v[236:239], v[104:119]
    ds_write_b128 v9, v[128:131] offset:40960
    ds_write_b128 v9, v[132:135] offset:41984
    v_mfma_f32_32x32x16_bf16 v[88:103], a[108:111], v[136:139], 0
    buffer_load_dwordx4 v[168:171], v11, s[24:27], s40 offen sc1
    buffer_load_dwordx4 v[172:175], v11, s[24:27], s41 offen sc1
    v_mfma_f32_32x32x16_bf16 v[72:87], a[104:107], v[136:139], v[24:39]
    s_nop 5
    ds_write_b128 v7, v[112:115] offset:24576
    ds_write_b128 v7, v[116:119] offset:25600
    buffer_load_dwordx4 v[176:179], v11, s[24:27], s42 offen sc1
    buffer_load_dwordx4 v[180:183], v11, s[24:27], s43 offen sc1
    s_waitcnt vmcnt(10)
    v_max3_u32 v15, v140, v142, v144
    v_max_u32 v15, v15, v146
    v_cmp_eq_u32 vcc, -1, v15
    v_fma_f32 v64, v48, v104, v64
    v_fma_f32 v65, v49, v105, v65
    v_fma_f32 v66, v50, v106, v66
    v_fma_f32 v67, v51, v107, v67
    v_fma_f32 v68, v52, v108, v68
    v_fma_f32 v69, v53, v109, v69
    v_fma_f32 v70, v54, v110, v70
    v_fma_f32 v71, v55, v111, v71
    s_cbranch_vccz C3_0_1K
C3_0_1R:
    buffer_load_dwordx4 v[140:143], v11, s[24:27], s33 offen sc1
    buffer_load_dwordx4 v[144:147], v11, s[24:27], s34 offen sc1
    s_sub_u32 s73, s73, 1
    s_cbranch_scc1 END
    s_waitcnt vmcnt(0)
    v_max3_u32 v15, v140, v142, v144
    v_max_u32 v15, v15, v146
    v_cmp_eq_u32 vcc, -1, v15
    s_cbranch_vccnz C3_0_1R
C3_0_1K:
    v_mfma_f32_32x32x16_bf16 v[88:103], a[116:119], v[140:143], v[88:103]
    buffer_load_dwordx4 v[184:187], v11, s[24:27], s44 offen sc1
    s_add_u32 m0, s71, 14336
    s_add_u32 s52, s52, 1384448
    buffer_load_dwordx4 v1, s[8:11], s52 offen lds
    s_waitcnt lgkmcnt(0)
    s_barrier
    ds_read_b128 v[120:123], v10 offset:32768
    ds_read_b128 v[128:131], v10 offset:40960
    ds_read_b128 v[112:115], v10 offset:24576
    v_mfma_f32_32x32x16_bf16 v[72:87], a[112:115], v[140:143], v[72:87]
    ds_read_b128 v[124:127], v10 offset:33792
    ds_read_b128 v[132:135], v10 offset:41984
    ds_read_b128 v[116:119], v10 offset:25600
    buffer_load_dwordx4 v2, s[8:11], s52 offen offset:1024 lds
    s_add_u32 m0, s71, 16384
    s_add_u32 s53, s53, 1384448
    buffer_load_dwordx4 v1, s[8:11], s53 offen lds
    v_mfma_f32_32x32x16_bf16 v[88:103], a[124:127], v[144:147], v[88:103]
    s_waitcnt lgkmcnt(5)
    v_fma_f32 v64, v48, v120, v64
    v_fma_f32 v65, v49, v121, v65
    v_fma_f32 v66, v50, v122, v66
    v_fma_f32 v67, v51, v123, v67
    s_waitcnt lgkmcnt(4)
    v_fma_f32 v64, v48, v128, v64
    v_fma_f32 v65, v49, v129, v65
    v_fma_f32 v66, v50, v130, v66
    v_fma_f32 v67, v51, v131, v67
    s_waitcnt lgkmcnt(3)
    v_fma_f32 v64, v48, v112, v64
    v_fma_f32 v65, v49, v113, v65
    v_fma_f32 v66, v50, v114, v66
    v_fma_f32 v67, v51, v115, v67
    v_cvt_pk_bf16_f32 v188, v64, v65
    v_cvt_pk_bf16_f32 v189, v66, v67
    v_min_u32 v188, -2, v188
    buffer_load_dwordx4 v2, s[8:11], s53 offen offset:1024 lds
    v_mfma_f32_32x32x16_bf16 v[72:87], a[120:123], v[144:147], v[72:87]
    s_waitcnt lgkmcnt(2)
    v_fma_f32 v68, v52, v124, v68
    v_fma_f32 v69, v53, v125, v69
    v_fma_f32 v70, v54, v126, v70
    v_fma_f32 v71, v55, v127, v71
    s_waitcnt lgkmcnt(1)
    v_fma_f32 v68, v52, v132, v68
    v_fma_f32 v69, v53, v133, v69
    v_fma_f32 v70, v54, v134, v70
    v_fma_f32 v71, v55, v135, v71
    s_waitcnt lgkmcnt(0)
    v_fma_f32 v68, v52, v116, v68
    v_fma_f32 v69, v53, v117, v69
    v_fma_f32 v70, v54, v118, v70
    v_fma_f32 v71, v55, v119, v71
    v_cvt_pk_bf16_f32 v190, v68, v69
    v_cvt_pk_bf16_f32 v191, v70, v71
    v_min_u32 v190, -2, v190
    s_waitcnt vmcnt(12)
    s_cmp_lg_u32 s78, 0
    s_cbranch_scc1 DS5A
    buffer_store_dwordx4 v[188:191], v12, s[24:27], s32 offen
DS5B:
    v_add_u32 v12, 53248, v12
    v_max3_u32 v15, v148, v150, v152
    v_max_u32 v15, v15, v154
    v_cmp_eq_u32 vcc, -1, v15
    s_cbranch_vccz C3_0_3K
C3_0_3R:
    buffer_load_dwordx4 v[148:151], v11, s[24:27], s35 offen sc1
    buffer_load_dwordx4 v[152:155], v11, s[24:27], s36 offen sc1
    s_sub_u32 s73, s73, 1
    s_cbranch_scc1 END
    s_waitcnt vmcnt(0)
    v_max3_u32 v15, v148, v150, v152
    v_max_u32 v15, v15, v154
    v_cmp_eq_u32 vcc, -1, v15
    s_cbranch_vccnz C3_0_3R
C3_0_3K:
    v_mfma_f32_32x32x16_bf16 v[88:103], a[132:135], v[148:151], v[88:103]
    s_add_u32 m0, s71, 18432
    s_add_u32 s54, s54, 1384448
    buffer_load_dwordx4 v1, s[8:11], s54 offen lds
    ds_read_b64_tr_b16 a[188:189], v4 offset:20480
    ds_read_b64_tr_b16 a[190:191], v4 offset:20992
    v_mfma_f32_32x32x16_bf16 v[72:87], a[128:131], v[148:151], v[72:87]
    buffer_load_dwordx4 v2, s[8:11], s54 offen offset:1024 lds
    ds_read_b64_tr_b16 a[184:185], v3 offset:20480
    ds_read_b64_tr_b16 a[186:187], v3 offset:20992
    v_mfma_f32_32x32x16_bf16 v[88:103], a[140:143], v[152:155], v[88:103]
    s_add_u32 m0, s71, 8192
    s_add_u32 s49, s49, 1384448
    buffer_load_dwordx4 v1, s[8:11], s49 offen lds
    ds_read_b64_tr_b16 a[196:197], v4 offset:22528
    v_mfma_f32_32x32x16_bf16 v[72:87], a[136:139], v[152:155], v[72:87]
    ds_read_b64_tr_b16 a[198:199], v4 offset:23040
    ds_read_b64_tr_b16 a[192:193], v3 offset:22528
    s_waitcnt vmcnt(14)
    v_max3_u32 v15, v156, v158, v160
    v_max_u32 v15, v15, v162
    v_cmp_eq_u32 vcc, -1, v15
    s_cbranch_vccz C3_0_5K
C3_0_5R:
    buffer_load_dwordx4 v[156:159], v11, s[24:27], s37 offen sc1
    buffer_load_dwordx4 v[160:163], v11, s[24:27], s38 offen sc1
    s_sub_u32 s73, s73, 1
    s_cbranch_scc1 END
    s_waitcnt vmcnt(0)
    v_max3_u32 v15, v156, v158, v160
    v_max_u32 v15, v15, v162
    v_cmp_eq_u32 vcc, -1, v15
    s_cbranch_vccnz C3_0_5R
C3_0_5K:
    v_mfma_f32_32x32x16_bf16 v[88:103], a[148:151], v[156:159], v[88:103]
    buffer_load_dwordx4 v2, s[8:11], s49 offen offset:1024 lds
    ds_read_b64_tr_b16 a[194:195], v3 offset:23040
    v_mfma_f32_32x32x16_bf16 v[72:87], a[144:147], v[156:159], v[72:87]
    s_add_u32 m0, s71, 10240
    s_add_u32 s50, s50, 1384448
    buffer_load_dwordx4 v1, s[8:11], s50 offen lds
    ds_read_b64_tr_b16 a[204:205], v4 offset:24576
    ds_read_b64_tr_b16 a[206:207], v4 offset:25088
    v_mfma_f32_32x32x16_bf16 v[88:103], a[156:159], v[160:163], v[88:103]
    buffer_load_dwordx4 v2, s[8:11], s50 offen offset:1024 lds
    ds_read_b64_tr_b16 a[200:201], v3 offset:24576
    v_mfma_f32_32x32x16_bf16 v[72:87], a[152:155], v[160:163], v[72:87]
    ds_read_b64_tr_b16 a[202:203], v3 offset:25088
    ds_read_b64_tr_b16 a[4:5], v4 offset:0
    s_waitcnt vmcnt(15)
    v_max3_u32 v15, v164, v166, v168
    v_max_u32 v15, v15, v170
    v_cmp_eq_u32 vcc, -1, v15
    s_cbranch_vccz C3_0_7K
C3_0_7R:
    buffer_load_dwordx4 v[164:167], v11, s[24:27], s39 offen sc1
    buffer_load_dwordx4 v[168:171], v11, s[24:27], s40 offen sc1
    s_sub_u32 s73, s73, 1
    s_cbranch_scc1 END
    s_waitcnt vmcnt(0)
    v_max3_u32 v15, v164, v166, v168
    v_max_u32 v15, v15, v170
    v_cmp_eq_u32 vcc, -1, v15
    s_cbranch_vccnz C3_0_7R
C3_0_7K:
    v_mfma_f32_32x32x16_bf16 v[88:103], a[164:167], v[164:167], v[88:103]
    s_add_u32 m0, s71, 12288
    s_add_u32 s51, s51, 1384448
    buffer_load_dwordx4 v1, s[8:11], s51 offen lds
    ds_read_b64_tr_b16 a[6:7], v4 offset:512
    v_mfma_f32_32x32x16_bf16 v[72:87], a[160:163], v[164:167], v[72:87]
    buffer_load_dwordx4 v2, s[8:11], s51 offen offset:1024 lds
    ds_read_b64_tr_b16 a[0:1], v3 offset:0
    ds_read_b64_tr_b16 a[2:3], v3 offset:512
    v_mfma_f32_32x32x16_bf16 v[88:103], a[172:175], v[168:171], v[88:103]
    buffer_load_dwordx4 v[192:195], v240, s[24:27], s33 offen sc1
    ds_read_b64_tr_b16 a[12:13], v4 offset:2048
    ds_read_b64_tr_b16 a[14:15], v4 offset:2560
    v_mfma_f32_32x32x16_bf16 v[72:87], a[168:171], v[168:171], v[72:87]
    ds_read_b64_tr_b16 a[8:9], v3 offset:2048
    s_waitcnt vmcnt(16)
    v_max3_u32 v15, v172, v174, v176
    v_max_u32 v15, v15, v178
    v_cmp_eq_u32 vcc, -1, v15
    s_cbranch_vccz C3_0_9K
C3_0_9R:
    buffer_load_dwordx4 v[172:175], v11, s[24:27], s41 offen sc1
    buffer_load_dwordx4 v[176:179], v11, s[24:27], s42 offen sc1
    s_sub_u32 s73, s73, 1
    s_cbranch_scc1 END
    s_waitcnt vmcnt(0)
    v_max3_u32 v15, v172, v174, v176
    v_max_u32 v15, v15, v178
    v_cmp_eq_u32 vcc, -1, v15
    s_cbranch_vccnz C3_0_9R
C3_0_9K:
    v_mfma_f32_32x32x16_bf16 v[88:103], a[180:183], v[172:175], v[88:103]
    buffer_load_dwordx4 v[196:199], v240, s[24:27], s34 offen sc1
    ds_read_b64_tr_b16 a[10:11], v3 offset:2560
    ds_read_b64_tr_b16 a[20:21], v4 offset:4096
    v_mfma_f32_32x32x16_bf16 v[72:87], a[176:179], v[172:175], v[72:87]
    buffer_load_dwordx4 v[200:203], v240, s[24:27], s35 offen sc1
    ds_read_b64_tr_b16 a[22:23], v4 offset:4608
    s_waitcnt lgkmcnt(15)
    v_mfma_f32_32x32x16_bf16 v[88:103], a[188:191], v[176:179], v[88:103]
    buffer_load_dwordx4 v[204:207], v240, s[24:27], s36 offen sc1
    ds_read_b64_tr_b16 a[16:17], v3 offset:4096
    ds_read_b64_tr_b16 a[18:19], v3 offset:4608
    s_waitcnt vmcnt(17)
    v_max3_u32 v15, v180, v182, v184
    v_max_u32 v15, v15, v186
    v_cmp_eq_u32 vcc, -1, v15
    s_cbranch_vccz C3_0_11K
C3_0_11R:
    buffer_load_dwordx4 v[180:183], v11, s[24:27], s43 offen sc1
    buffer_load_dwordx4 v[184:187], v11, s[24:27], s44 offen sc1
    s_sub_u32 s73, s73, 1
    s_cbranch_scc1 END
    s_waitcnt vmcnt(0)
    v_max3_u32 v15, v180, v182, v184
    v_max_u32 v15, v15, v186
    v_cmp_eq_u32 vcc, -1, v15
    s_cbranch_vccnz C3_0_11R
C3_0_11K:
    v_mfma_f32_32x32x16_bf16 v[88:103], a[196:199], v[180:183], v[88:103]
    ds_read_b64_tr_b16 a[28:29], v4 offset:6144
    s_waitcnt lgkmcnt(15)
    v_mfma_f32_32x32x16_bf16 v[88:103], a[204:207], v[184:187], v[88:103]
    s_cmp_lg_u32 s78, 0
    s_cbranch_scc1 PS7A
    buffer_store_dwordx4 v[248:251], v243, s[24:27], s32 offen
PS7B:
    v_add_u32 v243, 53248, v243
    buffer_load_dwordx4 v[208:211], v240, s[24:27], s37 offen sc1
    ds_read_b64_tr_b16 a[30:31], v4 offset:6656
    ds_read_b64_tr_b16 a[24:25], v3 offset:6144
    v_mfma_f32_32x32x16_bf16 v[72:87], a[184:187], v[176:179], v[72:87]
    buffer_load_dwordx4 v[212:215], v240, s[24:27], s38 offen sc1
    ds_read_b64_tr_b16 a[26:27], v3 offset:6656
    v_subrev_u32 v11, 159744, v11
    v_mfma_f32_32x32x16_bf16 v[72:87], a[192:195], v[180:183], v[72:87]
    ds_write_b128 v8, v[88:91] offset:8192
    ds_write_b128 v8, v[92:95] offset:9216
    buffer_load_dwordx4 v[216:219], v240, s[24:27], s39 offen sc1
    s_waitcnt lgkmcnt(15)
    v_mfma_f32_32x32x16_bf16 v[72:87], a[200:203], v[184:187], v[72:87]
    ds_write_b128 v9, v[96:99] offset:16384
    ds_write_b128 v9, v[100:103] offset:17408
    v_mfma_f32_32x32x16_bf16 v[120:135], a[108:111], v[188:191], 0
    buffer_load_dwordx4 v[220:223], v240, s[24:27], s40 offen sc1
    buffer_load_dwordx4 v[224:227], v240, s[24:27], s41 offen sc1
    v_mfma_f32_32x32x16_bf16 v[104:119], a[104:107], v[188:191], v[24:39]
    s_nop 5
    ds_write_b128 v7, v[80:83] offset:0
    ds_write_b128 v7, v[84:87] offset:1024
    buffer_load_dwordx4 v[228:231], v240, s[24:27], s42 offen sc1
    buffer_load_dwordx4 v[232:235], v240, s[24:27], s43 offen sc1
    s_waitcnt vmcnt(10)
    v_max3_u32 v15, v192, v194, v196
    v_max_u32 v15, v15, v198
    v_cmp_eq_u32 vcc, -1, v15
    v_fma_f32 v56, v40, v72, v56
    v_fma_f32 v57, v41, v73, v57
    v_fma_f32 v58, v42, v74, v58
    v_fma_f32 v59, v43, v75, v59
    v_fma_f32 v60, v44, v76, v60
    v_fma_f32 v61, v45, v77, v61
    v_fma_f32 v62, v46, v78, v62
    v_fma_f32 v63, v47, v79, v63
    s_cbranch_vccz C3_1_1K
C3_1_1R:
    buffer_load_dwordx4 v[192:195], v240, s[24:27], s33 offen sc1
    buffer_load_dwordx4 v[196:199], v240, s[24:27], s34 offen sc1
    s_sub_u32 s73, s73, 1
    s_cbranch_scc1 END
    s_waitcnt vmcnt(0)
    v_max3_u32 v15, v192, v194, v196
    v_max_u32 v15, v15, v198
    v_cmp_eq_u32 vcc, -1, v15
    s_cbranch_vccnz C3_1_1R
C3_1_1K:
    v_mfma_f32_32x32x16_bf16 v[120:135], a[116:119], v[192:195], v[120:135]
    buffer_load_dwordx4 v[236:239], v240, s[24:27], s44 offen sc1
    s_add_u32 m0, s71, 20480
    s_add_u32 s55, s55, 1384448
    buffer_load_dwordx4 v1, s[8:11], s55 offen lds
    s_waitcnt lgkmcnt(0)
    s_barrier
    ds_read_b128 v[88:91], v10 offset:8192
    ds_read_b128 v[96:99], v10 offset:16384
    ds_read_b128 v[80:83], v10 offset:0
    v_mfma_f32_32x32x16_bf16 v[104:119], a[112:115], v[192:195], v[104:119]
    ds_read_b128 v[92:95], v10 offset:9216
    ds_read_b128 v[100:103], v10 offset:17408
    ds_read_b128 v[84:87], v10 offset:1024
    buffer_load_dwordx4 v2, s[8:11], s55 offen offset:1024 lds
    s_add_u32 m0, s71, 22528
    s_add_u32 s56, s56, 1384448
    buffer_load_dwordx4 v1, s[8:11], s56 offen lds
    v_mfma_f32_32x32x16_bf16 v[120:135], a[124:127], v[196:199], v[120:135]
    s_waitcnt lgkmcnt(5)
    v_fma_f32 v56, v40, v88, v56
    v_fma_f32 v57, v41, v89, v57
    v_fma_f32 v58, v42, v90, v58
    v_fma_f32 v59, v43, v91, v59
    s_waitcnt lgkmcnt(4)
    v_fma_f32 v56, v40, v96, v56
    v_fma_f32 v57, v41, v97, v57
    v_fma_f32 v58, v42, v98, v58
    v_fma_f32 v59, v43, v99, v59
    s_waitcnt lgkmcnt(3)
    v_fma_f32 v56, v40, v80, v56
    v_fma_f32 v57, v41, v81, v57
    v_fma_f32 v58, v42, v82, v58
    v_fma_f32 v59, v43, v83, v59
    v_cvt_pk_bf16_f32 v136, v56, v57
    v_cvt_pk_bf16_f32 v137, v58, v59
    v_min_u32 v136, -2, v136
    buffer_load_dwordx4 v2, s[8:11], s56 offen offset:1024 lds
    v_mfma_f32_32x32x16_bf16 v[104:119], a[120:123], v[196:199], v[104:119]
    s_waitcnt lgkmcnt(2)
    v_fma_f32 v60, v44, v92, v60
    v_fma_f32 v61, v45, v93, v61
    v_fma_f32 v62, v46, v94, v62
    v_fma_f32 v63, v47, v95, v63
    s_waitcnt lgkmcnt(1)
    v_fma_f32 v60, v44, v100, v60
    v_fma_f32 v61, v45, v101, v61
    v_fma_f32 v62, v46, v102, v62
    v_fma_f32 v63, v47, v103, v63
    s_waitcnt lgkmcnt(0)
    v_fma_f32 v60, v44, v84, v60
    v_fma_f32 v61, v45, v85, v61
    v_fma_f32 v62, v46, v86, v62
    v_fma_f32 v63, v47, v87, v63
    v_cvt_pk_bf16_f32 v138, v60, v61
    v_cvt_pk_bf16_f32 v139, v62, v63
    v_min_u32 v138, -2, v138
    s_waitcnt vmcnt(12)
    s_cmp_lg_u32 s78, 0
    s_cbranch_scc1 DS6A
    buffer_store_dwordx4 v[136:139], v12, s[24:27], s32 offen
DS6B:
    v_add_u32 v12, 53248, v12
    v_max3_u32 v15, v200, v202, v204
    v_max_u32 v15, v15, v206
    v_cmp_eq_u32 vcc, -1, v15
    s_cbranch_vccz C3_1_3K
C3_1_3R:
    buffer_load_dwordx4 v[200:203], v240, s[24:27], s35 offen sc1
    buffer_load_dwordx4 v[204:207], v240, s[24:27], s36 offen sc1
    s_sub_u32 s73, s73, 1
    s_cbranch_scc1 END
    s_waitcnt vmcnt(0)
    v_max3_u32 v15, v200, v202, v204
    v_max_u32 v15, v15, v206
    v_cmp_eq_u32 vcc, -1, v15
    s_cbranch_vccnz C3_1_3R
C3_1_3K:
    v_mfma_f32_32x32x16_bf16 v[120:135], a[132:135], v[200:203], v[120:135]
    s_add_u32 m0, s71, 24576
    s_add_u32 s57, s57, 1384448
    buffer_load_dwordx4 v1, s[8:11], s57 offen lds
    ds_read_b64_tr_b16 a[60:61], v4 offset:14336
    ds_read_b64_tr_b16 a[62:63], v4 offset:14848
    v_mfma_f32_32x32x16_bf16 v[104:119], a[128:131], v[200:203], v[104:119]
    buffer_load_dwordx4 v2, s[8:11], s57 offen offset:1024 lds
    ds_read_b64_tr_b16 a[56:57], v3 offset:14336
    v_mfma_f32_32x32x16_bf16 v[120:135], a[140:143], v[204:207], v[120:135]
    s_add_u32 m0, s71, 2048
    s_add_u32 s46, s46, 1384448
    buffer_load_dwordx4 v1, s[8:11], s46 offen lds
    ds_read_b64_tr_b16 a[58:59], v3 offset:14848
    v_mfma_f32_32x32x16_bf16 v[104:119], a[136:139], v[204:207], v[104:119]
    buffer_load_dwordx4 v2, s[8:11], s46 offen offset:1024 lds
    ds_read_b64_tr_b16 a[68:69], v4 offset:16384
    ds_read_b64_tr_b16 a[70:71], v4 offset:16896
    s_waitcnt vmcnt(15)
    v_max3_u32 v15, v208, v210, v212
    v_max_u32 v15, v15, v214
    v_cmp_eq_u32 vcc, -1, v15
    s_cbranch_vccz C3_1_5K
C3_1_5R:
    buffer_load_dwordx4 v[208:211], v240, s[24:27], s37 offen sc1
    buffer_load_dwordx4 v[212:215], v240, s[24:27], s38 offen sc1
    s_sub_u32 s73, s73, 1
    s_cbranch_scc1 END
    s_waitcnt vmcnt(0)
    v_max3_u32 v15, v208, v210, v212
    v_max_u32 v15, v15, v214
    v_cmp_eq_u32 vcc, -1, v15
    s_cbranch_vccnz C3_1_5R
C3_1_5K:
    v_mfma_f32_32x32x16_bf16 v[120:135], a[148:151], v[208:211], v[120:135]
    s_add_u32 m0, s71, 4096
    s_add_u32 s47, s47, 1384448
    buffer_load_dwordx4 v1, s[8:11], s47 offen lds
    ds_read_b64_tr_b16 a[64:65], v3 offset:16384
    v_mfma_f32_32x32x16_bf16 v[104:119], a[144:147], v[208:211], v[104:119]
    buffer_load_dwordx4 v2, s[8:11], s47 offen offset:1024 lds
    ds_read_b64_tr_b16 a[66:67], v3 offset:16896
    v_mfma_f32_32x32x16_bf16 v[120:135], a[156:159], v[212:215], v[120:135]
    ds_read_b64_tr_b16 a[76:77], v4 offset:18432
    ds_read_b64_tr_b16 a[78:79], v4 offset:18944
    v_mfma_f32_32x32x16_bf16 v[104:119], a[152:155], v[212:215], v[104:119]
    s_add_u32 m0, s71, 6144
    s_add_u32 s48, s48, 1384448
    buffer_load_dwordx4 v1, s[8:11], s48 offen lds
    ds_read_b64_tr_b16 a[72:73], v3 offset:18432
    s_waitcnt vmcnt(16)
    v_max3_u32 v15, v216, v218, v220
    v_max_u32 v15, v15, v222
    v_cmp_eq_u32 vcc, -1, v15
    s_cbranch_vccz C3_1_7K
C3_1_7R:
    buffer_load_dwordx4 v[216:219], v240, s[24:27], s39 offen sc1
    buffer_load_dwordx4 v[220:223], v240, s[24:27], s40 offen sc1
    s_sub_u32 s73, s73, 1
    s_cbranch_scc1 END
    s_waitcnt vmcnt(0)
    v_max3_u32 v15, v216, v218, v220
    v_max_u32 v15, v15, v222
    v_cmp_eq_u32 vcc, -1, v15
    s_cbranch_vccnz C3_1_7R
C3_1_7K:
    v_mfma_f32_32x32x16_bf16 v[120:135], a[164:167], v[216:219], v[120:135]
    buffer_load_dwordx4 v2, s[8:11], s48 offen offset:1024 lds
    ds_read_b64_tr_b16 a[74:75], v3 offset:18944
    ds_read_b128 v[16:19], v14 offset:128
    v_mfma_f32_32x32x16_bf16 v[104:119], a[160:163], v[216:219], v[104:119]
    s_add_u32 m0, s71, 0
    s_add_u32 s45, s45, 1384448
    buffer_load_dwordx4 v1, s[8:11], s45 offen lds
    ds_read_b64_tr_b16 a[36:37], v4 offset:8192
    ds_read_b64_tr_b16 a[38:39], v4 offset:8704
    v_mfma_f32_32x32x16_bf16 v[120:135], a[172:175], v[220:223], v[120:135]
    buffer_load_dwordx4 v2, s[8:11], s45 offen offset:1024 lds
    ds_read_b64_tr_b16 a[32:33], v3 offset:8192
    v_mfma_f32_32x32x16_bf16 v[104:119], a[168:171], v[220:223], v[104:119]
    buffer_load_dwordx4 v[140:143], v11, s[24:27], s33 offen sc1
    ds_read_b64_tr_b16 a[34:35], v3 offset:8704
    s_waitcnt vmcnt(18)
    v_max3_u32 v15, v224, v226, v228
    v_max_u32 v15, v15, v230
    v_cmp_eq_u32 vcc, -1, v15
    s_cbranch_vccz C3_1_9K
C3_1_9R:
    buffer_load_dwordx4 v[224:227], v240, s[24:27], s41 offen sc1
    buffer_load_dwordx4 v[228:231], v240, s[24:27], s42 offen sc1
    s_sub_u32 s73, s73, 1
    s_cbranch_scc1 END
    s_waitcnt vmcnt(0)
    v_max3_u32 v15, v224, v226, v228
    v_max_u32 v15, v15, v230
    v_cmp_eq_u32 vcc, -1, v15
    s_cbranch_vccnz C3_1_9R
C3_1_9K:
    v_mfma_f32_32x32x16_bf16 v[120:135], a[180:183], v[224:227], v[120:135]
    buffer_load_dwordx4 v[144:147], v11, s[24:27], s34 offen sc1
    ds_read_b64_tr_b16 a[44:45], v4 offset:10240
    ds_read_b64_tr_b16 a[46:47], v4 offset:10752
    v_mfma_f32_32x32x16_bf16 v[104:119], a[176:179], v[224:227], v[104:119]
    ds_read_b64_tr_b16 a[40:41], v3 offset:10240
    v_mfma_f32_32x32x16_bf16 v[120:135], a[188:191], v[228:231], v[120:135]
    buffer_load_dwordx4 v[148:151], v11, s[24:27], s35 offen sc1
    ds_read_b64_tr_b16 a[42:43], v3 offset:10752
    s_waitcnt vmcnt(18)
    v_max3_u32 v15, v232, v234, v236
    v_max_u32 v15, v15, v238
    v_cmp_eq_u32 vcc, -1, v15
    s_cbranch_vccz C3_1_11K
C3_1_11R:
    buffer_load_dwordx4 v[232:235], v240, s[24:27], s43 offen sc1
    buffer_load_dwordx4 v[236:239], v240, s[24:27], s44 offen sc1
    s_sub_u32 s73, s73, 1
    s_cbranch_scc1 END
    s_waitcnt vmcnt(0)
    v_max3_u32 v15, v232, v234, v236
    v_max_u32 v15, v15, v238
    v_cmp_eq_u32 vcc, -1, v15
    s_cbranch_vccnz C3_1_11R
C3_1_11K:
    v_mfma_f32_32x32x16_bf16 v[120:135], a[196:199], v[232:235], v[120:135]
    buffer_load_dwordx4 v[152:155], v11, s[24:27], s36 offen sc1
    ds_read_b64_tr_b16 a[52:53], v4 offset:12288
    ds_read_b64_tr_b16 a[54:55], v4 offset:12800
    s_waitcnt lgkmcnt(10)
    v_lshlrev_b32 v24, 16, v16
    v_and_b32 v25, 0xffff0000, v16
    v_mfma_f32_32x32x16_bf16 v[120:135], a[204:207], v[236:239], v[120:135]
    s_cmp_lg_u32 s78, 0
    s_cbranch_scc1 PS8A
    buffer_store_dwordx4 v[248:251], v243, s[24:27], s32 offen
PS8B:
    v_add_u32 v243, 53248, v243
    buffer_load_dwordx4 v[156:159], v11, s[24:27], s37 offen sc1
    ds_read_b64_tr_b16 a[48:49], v3 offset:12288
    v_lshlrev_b32 v26, 16, v17
    v_and_b32 v27, 0xffff0000, v17
    v_lshlrev_b32 v28, 16, v18
    v_mfma_f32_32x32x16_bf16 v[104:119], a[184:187], v[228:231], v[104:119]
    buffer_load_dwordx4 v[160:163], v11, s[24:27], s38 offen sc1
    ds_read_b64_tr_b16 a[50:51], v3 offset:12800
    v_add_u32 v240, 106496, v240
    v_and_b32 v29, 0xffff0000, v18
    v_lshlrev_b32 v30, 16, v19
    v_and_b32 v31, 0xffff0000, v19
    v_mfma_f32_32x32x16_bf16 v[104:119], a[192:195], v[232:235], v[104:119]
    ds_write_b128 v8, v[120:123] offset:32768
    ds_write_b128 v8, v[124:127] offset:33792
    buffer_load_dwordx4 v[164:167], v11, s[24:27], s39 offen sc1
    v_mfma_f32_32x32x16_bf16 v[104:119], a[200:203], v[236:239], v[104:119]
    ds_write_b128 v9, v[128:131] offset:40960
    ds_write_b128 v9, v[132:135] offset:41984
    v_mfma_f32_32x32x16_bf16 v[88:103], a[4:7], v[136:139], 0
    buffer_load_dwordx4 v[168:171], v11, s[24:27], s40 offen sc1
    buffer_load_dwordx4 v[172:175], v11, s[24:27], s41 offen sc1
    v_mfma_f32_32x32x16_bf16 v[72:87], a[0:3], v[136:139], v[24:39]
    s_nop 5
    ds_write_b128 v7, v[112:115] offset:24576
    ds_write_b128 v7, v[116:119] offset:25600
    buffer_load_dwordx4 v[176:179], v11, s[24:27], s42 offen sc1
    buffer_load_dwordx4 v[180:183], v11, s[24:27], s43 offen sc1
    s_waitcnt vmcnt(10)
    v_max3_u32 v15, v140, v142, v144
    v_max_u32 v15, v15, v146
    v_cmp_eq_u32 vcc, -1, v15
    v_fma_f32 v64, v48, v104, v64
    v_fma_f32 v65, v49, v105, v65
    v_fma_f32 v66, v50, v106, v66
    v_fma_f32 v67, v51, v107, v67
    v_fma_f32 v68, v52, v108, v68
    v_fma_f32 v69, v53, v109, v69
    v_fma_f32 v70, v54, v110, v70
    v_fma_f32 v71, v55, v111, v71
    s_cbranch_vccz C4_0_1K
C4_0_1R:
    buffer_load_dwordx4 v[140:143], v11, s[24:27], s33 offen sc1
    buffer_load_dwordx4 v[144:147], v11, s[24:27], s34 offen sc1
    s_sub_u32 s73, s73, 1
    s_cbranch_scc1 END
    s_waitcnt vmcnt(0)
    v_max3_u32 v15, v140, v142, v144
    v_max_u32 v15, v15, v146
    v_cmp_eq_u32 vcc, -1, v15
    s_cbranch_vccnz C4_0_1R
C4_0_1K:
    v_mfma_f32_32x32x16_bf16 v[88:103], a[12:15], v[140:143], v[88:103]
    buffer_load_dwordx4 v[184:187], v11, s[24:27], s44 offen sc1
    s_add_u32 m0, s71, 14336
    s_add_u32 s52, s52, 1384448
    buffer_load_dwordx4 v1, s[8:11], s52 offen lds
    s_waitcnt lgkmcnt(0)
    s_barrier
    ds_read_b128 v[120:123], v10 offset:32768
    ds_read_b128 v[128:131], v10 offset:40960
    ds_read_b128 v[112:115], v10 offset:24576
    v_mfma_f32_32x32x16_bf16 v[72:87], a[8:11], v[140:143], v[72:87]
    ds_read_b128 v[124:127], v10 offset:33792
    ds_read_b128 v[132:135], v10 offset:41984
    ds_read_b128 v[116:119], v10 offset:25600
    buffer_load_dwordx4 v2, s[8:11], s52 offen offset:1024 lds
    s_add_u32 m0, s71, 16384
    s_add_u32 s53, s53, 1384448
    buffer_load_dwordx4 v1, s[8:11], s53 offen lds
    v_mfma_f32_32x32x16_bf16 v[88:103], a[20:23], v[144:147], v[88:103]
    s_waitcnt lgkmcnt(5)
    v_fma_f32 v64, v48, v120, v64
    v_fma_f32 v65, v49, v121, v65
    v_fma_f32 v66, v50, v122, v66
    v_fma_f32 v67, v51, v123, v67
    s_waitcnt lgkmcnt(4)
    v_fma_f32 v64, v48, v128, v64
    v_fma_f32 v65, v49, v129, v65
    v_fma_f32 v66, v50, v130, v66
    v_fma_f32 v67, v51, v131, v67
    s_waitcnt lgkmcnt(3)
    v_fma_f32 v64, v48, v112, v64
    v_fma_f32 v65, v49, v113, v65
    v_fma_f32 v66, v50, v114, v66
    v_fma_f32 v67, v51, v115, v67
    v_cvt_pk_bf16_f32 v188, v64, v65
    v_cvt_pk_bf16_f32 v189, v66, v67
    v_min_u32 v188, -2, v188
    buffer_load_dwordx4 v2, s[8:11], s53 offen offset:1024 lds
    v_mfma_f32_32x32x16_bf16 v[72:87], a[16:19], v[144:147], v[72:87]
    s_waitcnt lgkmcnt(2)
    v_fma_f32 v68, v52, v124, v68
    v_fma_f32 v69, v53, v125, v69
    v_fma_f32 v70, v54, v126, v70
    v_fma_f32 v71, v55, v127, v71
    s_waitcnt lgkmcnt(1)
    v_fma_f32 v68, v52, v132, v68
    v_fma_f32 v69, v53, v133, v69
    v_fma_f32 v70, v54, v134, v70
    v_fma_f32 v71, v55, v135, v71
    s_waitcnt lgkmcnt(0)
    v_fma_f32 v68, v52, v116, v68
    v_fma_f32 v69, v53, v117, v69
    v_fma_f32 v70, v54, v118, v70
    v_fma_f32 v71, v55, v119, v71
    v_cvt_pk_bf16_f32 v190, v68, v69
    v_cvt_pk_bf16_f32 v191, v70, v71
    v_min_u32 v190, -2, v190
    s_waitcnt vmcnt(12)
    s_cmp_lg_u32 s78, 0
    s_cbranch_scc1 DS7A
    buffer_store_dwordx4 v[188:191], v12, s[24:27], s32 offen
DS7B:
    v_add_u32 v12, 53248, v12
    v_max3_u32 v15, v148, v150, v152
    v_max_u32 v15, v15, v154
    v_cmp_eq_u32 vcc, -1, v15
    s_cbranch_vccz C4_0_3K
C4_0_3R:
    buffer_load_dwordx4 v[148:151], v11, s[24:27], s35 offen sc1
    buffer_load_dwordx4 v[152:155], v11, s[24:27], s36 offen sc1
    s_sub_u32 s73, s73, 1
    s_cbranch_scc1 END
    s_waitcnt vmcnt(0)
    v_max3_u32 v15, v148, v150, v152
    v_max_u32 v15, v15, v154
    v_cmp_eq_u32 vcc, -1, v15
    s_cbranch_vccnz C4_0_3R
C4_0_3K:
    v_mfma_f32_32x32x16_bf16 v[88:103], a[28:31], v[148:151], v[88:103]
    s_add_u32 m0, s71, 18432
    s_add_u32 s54, s54, 1384448
    buffer_load_dwordx4 v1, s[8:11], s54 offen lds
    ds_read_b64_tr_b16 a[84:85], v4 offset:20480
    ds_read_b64_tr_b16 a[86:87], v4 offset:20992
    v_mfma_f32_32x32x16_bf16 v[72:87], a[24:27], v[148:151], v[72:87]
    buffer_load_dwordx4 v2, s[8:11], s54 offen offset:1024 lds
    ds_read_b64_tr_b16 a[80:81], v3 offset:20480
    ds_read_b64_tr_b16 a[82:83], v3 offset:20992
    v_mfma_f32_32x32x16_bf16 v[88:103], a[36:39], v[152:155], v[88:103]
    s_add_u32 m0, s71, 8192
    s_add_u32 s49, s49, 1384448
    buffer_load_dwordx4 v1, s[8:11], s49 offen lds
    ds_read_b64_tr_b16 a[92:93], v4 offset:22528
    v_mfma_f32_32x32x16_bf16 v[72:87], a[32:35], v[152:155], v[72:87]
    ds_read_b64_tr_b16 a[94:95], v4 offset:23040
    ds_read_b64_tr_b16 a[88:89], v3 offset:22528
    s_waitcnt vmcnt(14)
    v_max3_u32 v15, v156, v158, v160
    v_max_u32 v15, v15, v162
    v_cmp_eq_u32 vcc, -1, v15
    s_cbranch_vccz C4_0_5K
C4_0_5R:
    buffer_load_dwordx4 v[156:159], v11, s[24:27], s37 offen sc1
    buffer_load_dwordx4 v[160:163], v11, s[24:27], s38 offen sc1
    s_sub_u32 s73, s73, 1
    s_cbranch_scc1 END
    s_waitcnt vmcnt(0)
    v_max3_u32 v15, v156, v158, v160
    v_max_u32 v15, v15, v162
    v_cmp_eq_u32 vcc, -1, v15
    s_cbranch_vccnz C4_0_5R
C4_0_5K:
    v_mfma_f32_32x32x16_bf16 v[88:103], a[44:47], v[156:159], v[88:103]
    buffer_load_dwordx4 v2, s[8:11], s49 offen offset:1024 lds
    ds_read_b64_tr_b16 a[90:91], v3 offset:23040
    v_mfma_f32_32x32x16_bf16 v[72:87], a[40:43], v[156:159], v[72:87]
    s_add_u32 m0, s71, 10240
    s_add_u32 s50, s50, 1384448
    buffer_load_dwordx4 v1, s[8:11], s50 offen lds
    ds_read_b64_tr_b16 a[100:101], v4 offset:24576
    ds_read_b64_tr_b16 a[102:103], v4 offset:25088
    v_mfma_f32_32x32x16_bf16 v[88:103], a[52:55], v[160:163], v[88:103]
    buffer_load_dwordx4 v2, s[8:11], s50 offen offset:1024 lds
    ds_read_b64_tr_b16 a[96:97], v3 offset:24576
    v_mfma_f32_32x32x16_bf16 v[72:87], a[48:51], v[160:163], v[72:87]
    ds_read_b64_tr_b16 a[98:99], v3 offset:25088
    ds_read_b64_tr_b16 a[108:109], v4 offset:0
    s_waitcnt vmcnt(15)
    v_max3_u32 v15, v164, v166, v168
    v_max_u32 v15, v15, v170
    v_cmp_eq_u32 vcc, -1, v15
    s_cbranch_vccz C4_0_7K
C4_0_7R:
    buffer_load_dwordx4 v[164:167], v11, s[24:27], s39 offen sc1
    buffer_load_dwordx4 v[168:171], v11, s[24:27], s40 offen sc1
    s_sub_u32 s73, s73, 1
    s_cbranch_scc1 END
    s_waitcnt vmcnt(0)
    v_max3_u32 v15, v164, v166, v168
    v_max_u32 v15, v15, v170
    v_cmp_eq_u32 vcc, -1, v15
    s_cbranch_vccnz C4_0_7R
C4_0_7K:
    v_mfma_f32_32x32x16_bf16 v[88:103], a[60:63], v[164:167], v[88:103]
    s_add_u32 m0, s71, 12288
    s_add_u32 s51, s51, 1384448
    buffer_load_dwordx4 v1, s[8:11], s51 offen lds
    ds_read_b64_tr_b16 a[110:111], v4 offset:512
    v_mfma_f32_32x32x16_bf16 v[72:87], a[56:59], v[164:167], v[72:87]
    buffer_load_dwordx4 v2, s[8:11], s51 offen offset:1024 lds
    ds_read_b64_tr_b16 a[104:105], v3 offset:0
    ds_read_b64_tr_b16 a[106:107], v3 offset:512
    v_mfma_f32_32x32x16_bf16 v[88:103], a[68:71], v[168:171], v[88:103]
    buffer_load_dwordx4 v[192:195], v240, s[24:27], s33 offen sc1
    ds_read_b64_tr_b16 a[116:117], v4 offset:2048
    ds_read_b64_tr_b16 a[118:119], v4 offset:2560
    v_mfma_f32_32x32x16_bf16 v[72:87], a[64:67], v[168:171], v[72:87]
    ds_read_b64_tr_b16 a[112:113], v3 offset:2048
    s_waitcnt vmcnt(16)
    v_max3_u32 v15, v172, v174, v176
    v_max_u32 v15, v15, v178
    v_cmp_eq_u32 vcc, -1, v15
    s_cbranch_vccz C4_0_9K
C4_0_9R:
    buffer_load_dwordx4 v[172:175], v11, s[24:27], s41 offen sc1
    buffer_load_dwordx4 v[176:179], v11, s[24:27], s42 offen sc1
    s_sub_u32 s73, s73, 1
    s_cbranch_scc1 END
    s_waitcnt vmcnt(0)
    v_max3_u32 v15, v172, v174, v176
    v_max_u32 v15, v15, v178
    v_cmp_eq_u32 vcc, -1, v15
    s_cbranch_vccnz C4_0_9R
C4_0_9K:
    v_mfma_f32_32x32x16_bf16 v[88:103], a[76:79], v[172:175], v[88:103]
    buffer_load_dwordx4 v[196:199], v240, s[24:27], s34 offen sc1
    ds_read_b64_tr_b16 a[114:115], v3 offset:2560
    ds_read_b64_tr_b16 a[124:125], v4 offset:4096
    v_mfma_f32_32x32x16_bf16 v[72:87], a[72:75], v[172:175], v[72:87]
    buffer_load_dwordx4 v[200:203], v240, s[24:27], s35 offen sc1
    ds_read_b64_tr_b16 a[126:127], v4 offset:4608
    s_waitcnt lgkmcnt(15)
    v_mfma_f32_32x32x16_bf16 v[88:103], a[84:87], v[176:179], v[88:103]
    buffer_load_dwordx4 v[204:207], v240, s[24:27], s36 offen sc1
    ds_read_b64_tr_b16 a[120:121], v3 offset:4096
    ds_read_b64_tr_b16 a[122:123], v3 offset:4608
    s_waitcnt vmcnt(17)
    v_max3_u32 v15, v180, v182, v184
    v_max_u32 v15, v15, v186
    v_cmp_eq_u32 vcc, -1, v15
    s_cbranch_vccz C4_0_11K
C4_0_11R:
    buffer_load_dwordx4 v[180:183], v11, s[24:27], s43 offen sc1
    buffer_load_dwordx4 v[184:187], v11, s[24:27], s44 offen sc1
    s_sub_u32 s73, s73, 1
    s_cbranch_scc1 END
    s_waitcnt vmcnt(0)
    v_max3_u32 v15, v180, v182, v184
    v_max_u32 v15, v15, v186
    v_cmp_eq_u32 vcc, -1, v15
    s_cbranch_vccnz C4_0_11R
C4_0_11K:
    v_mfma_f32_32x32x16_bf16 v[88:103], a[92:95], v[180:183], v[88:103]
    ds_read_b64_tr_b16 a[132:133], v4 offset:6144
    s_waitcnt lgkmcnt(15)
    v_mfma_f32_32x32x16_bf16 v[88:103], a[100:103], v[184:187], v[88:103]
    s_cmp_lg_u32 s78, 0
    s_cbranch_scc1 PS9A
    buffer_store_dwordx4 v[248:251], v243, s[24:27], s32 offen
PS9B:
    v_subrev_u32 v243, 212992, v243
    buffer_load_dwordx4 v[208:211], v240, s[24:27], s37 offen sc1
    ds_read_b64_tr_b16 a[134:135], v4 offset:6656
    ds_read_b64_tr_b16 a[128:129], v3 offset:6144
    v_mfma_f32_32x32x16_bf16 v[72:87], a[80:83], v[176:179], v[72:87]
    buffer_load_dwordx4 v[212:215], v240, s[24:27], s38 offen sc1
    ds_read_b64_tr_b16 a[130:131], v3 offset:6656
    v_add_u32 v11, 106496, v11
    v_mfma_f32_32x32x16_bf16 v[72:87], a[88:91], v[180:183], v[72:87]
    ds_write_b128 v8, v[88:91] offset:8192
    ds_write_b128 v8, v[92:95] offset:9216
    buffer_load_dwordx4 v[216:219], v240, s[24:27], s39 offen sc1
    s_waitcnt lgkmcnt(15)
    v_mfma_f32_32x32x16_bf16 v[72:87], a[96:99], v[184:187], v[72:87]
    ds_write_b128 v9, v[96:99] offset:16384
    ds_write_b128 v9, v[100:103] offset:17408
    v_mfma_f32_32x32x16_bf16 v[120:135], a[4:7], v[188:191], 0
    buffer_load_dwordx4 v[220:223], v240, s[24:27], s40 offen sc1
    s_add_u32 m0, s71, 20480
    s_add_u32 s55, s55, 1384448
    buffer_load_dwordx4 v1, s[8:11], s55 offen lds
    v_mfma_f32_32x32x16_bf16 v[104:119], a[0:3], v[188:191], v[24:39]
    s_nop 3
    ds_write_b128 v7, v[80:83] offset:0
    ds_write_b128 v7, v[84:87] offset:1024
    buffer_load_dwordx4 v[224:227], v240, s[24:27], s41 offen sc1
    s_waitcnt vmcnt(8)
    v_max3_u32 v15, v192, v194, v196
    v_max3_u32 v15, v15, v198, v200
    v_max_u32 v15, v15, v202
    v_cmp_eq_u32 vcc, -1, v15
    v_fma_f32 v56, v40, v72, v56
    v_fma_f32 v57, v41, v73, v57
    v_fma_f32 v58, v42, v74, v58
    v_fma_f32 v59, v43, v75, v59
    v_fma_f32 v60, v44, v76, v60
    v_fma_f32 v61, v45, v77, v61
    v_fma_f32 v62, v46, v78, v62
    v_fma_f32 v63, v47, v79, v63
    s_cbranch_vccz C4_1_1K
C4_1_1R:
    buffer_load_dwordx4 v[192:195], v240, s[24:27], s33 offen sc1
    buffer_load_dwordx4 v[196:199], v240, s[24:27], s34 offen sc1
    buffer_load_dwordx4 v[200:203], v240, s[24:27], s35 offen sc1
    s_sub_u32 s73, s73, 1
    s_cbranch_scc1 END
    s_waitcnt vmcnt(0)
    v_max3_u32 v15, v192, v194, v196
    v_max3_u32 v15, v15, v198, v200
    v_max_u32 v15, v15, v202
    v_cmp_eq_u32 vcc, -1, v15
    s_cbranch_vccnz C4_1_1R
C4_1_1K:
    v_mfma_f32_32x32x16_bf16 v[120:135], a[12:15], v[192:195], v[120:135]
    buffer_load_dwordx4 v[228:231], v240, s[24:27], s42 offen sc1
    buffer_load_dwordx4 v2, s[8:11], s55 offen offset:1024 lds
    s_waitcnt lgkmcnt(0)
    s_barrier
    ds_read_b128 v[88:91], v10 offset:8192
    ds_read_b128 v[96:99], v10 offset:16384
    ds_read_b128 v[80:83], v10 offset:0
    v_mfma_f32_32x32x16_bf16 v[104:119], a[8:11], v[192:195], v[104:119]
    ds_read_b128 v[92:95], v10 offset:9216
    ds_read_b128 v[100:103], v10 offset:17408
    ds_read_b128 v[84:87], v10 offset:1024
    buffer_load_dwordx4 v[232:235], v240, s[24:27], s43 offen sc1
    v_mfma_f32_32x32x16_bf16 v[120:135], a[20:23], v[196:199], v[120:135]
    s_waitcnt lgkmcnt(5)
    v_fma_f32 v56, v40, v88, v56
    v_fma_f32 v57, v41, v89, v57
    v_fma_f32 v58, v42, v90, v58
    v_fma_f32 v59, v43, v91, v59
    s_waitcnt lgkmcnt(4)
    v_fma_f32 v56, v40, v96, v56
    v_fma_f32 v57, v41, v97, v57
    v_fma_f32 v58, v42, v98, v58
    v_fma_f32 v59, v43, v99, v59
    s_waitcnt lgkmcnt(3)
    v_fma_f32 v56, v40, v80, v56
    buffer_load_dwordx4 v[236:239], v240, s[24:27], s44 offen sc1
    s_add_u32 m0, s71, 22528
    s_add_u32 s56, s56, 1384448
    buffer_load_dwordx4 v1, s[8:11], s56 offen lds
    v_mfma_f32_32x32x16_bf16 v[104:119], a[16:19], v[196:199], v[104:119]
    v_fma_f32 v57, v41, v81, v57
    v_fma_f32 v58, v42, v82, v58
    v_fma_f32 v59, v43, v83, v59
    v_cvt_pk_bf16_f32 v136, v56, v57
    v_cvt_pk_bf16_f32 v137, v58, v59
    v_min_u32 v136, -2, v136
    s_waitcnt lgkmcnt(2)
    v_fma_f32 v60, v44, v92, v60
    v_fma_f32 v61, v45, v93, v61
    v_fma_f32 v62, v46, v94, v62
    v_fma_f32 v63, v47, v95, v63
    s_waitcnt lgkmcnt(1)
    v_mfma_f32_32x32x16_bf16 v[120:135], a[28:31], v[200:203], v[120:135]
    v_fma_f32 v60, v44, v100, v60
    v_fma_f32 v61, v45, v101, v61
    v_fma_f32 v62, v46, v102, v62
    v_fma_f32 v63, v47, v103, v63
    s_waitcnt lgkmcnt(0)
    v_fma_f32 v60, v44, v84, v60
    v_fma_f32 v61, v45, v85, v61
    v_fma_f32 v62, v46, v86, v62
    v_fma_f32 v63, v47, v87, v63
    v_cvt_pk_bf16_f32 v138, v60, v61
    v_cvt_pk_bf16_f32 v139, v62, v63
    v_min_u32 v138, -2, v138
    s_waitcnt vmcnt(11)
    s_cmp_lg_u32 s78, 0
    s_cbranch_scc1 DS8A
    buffer_store_dwordx4 v[136:139], v12, s[24:27], s32 offen
DS8B:
    v_add_u32 v12, 53248, v12
    buffer_load_dwordx4 v2, s[8:11], s56 offen offset:1024 lds
    v_mfma_f32_32x32x16_bf16 v[104:119], a[24:27], v[200:203], v[104:119]
    s_waitcnt vmcnt(11)
    v_max3_u32 v15, v204, v206, v208
    v_max3_u32 v15, v15, v210, v212
    v_max_u32 v15, v15, v214
    v_cmp_eq_u32 vcc, -1, v15
    s_cbranch_vccz C4_1_4K
C4_1_4R:
    buffer_load_dwordx4 v[204:207], v240, s[24:27], s36 offen sc1
    buffer_load_dwordx4 v[208:211], v240, s[24:27], s37 offen sc1
    buffer_load_dwordx4 v[212:215], v240, s[24:27], s38 offen sc1
    s_sub_u32 s73, s73, 1
    s_cbranch_scc1 END
    s_waitcnt vmcnt(0)
    v_max3_u32 v15, v204, v206, v208
    v_max3_u32 v15, v15, v210, v212
    v_max_u32 v15, v15, v214
    v_cmp_eq_u32 vcc, -1, v15
    s_cbranch_vccnz C4_1_4R
C4_1_4K:
    v_mfma_f32_32x32x16_bf16 v[120:135], a[36:39], v[204:207], v[120:135]
    s_add_u32 m0, s71, 24576
    s_add_u32 s57, s57, 1384448
    buffer_load_dwordx4 v1, s[8:11], s57 offen lds
    v_mfma_f32_32x32x16_bf16 v[104:119], a[32:35], v[204:207], v[104:119]
    v_mfma_f32_32x32x16_bf16 v[120:135], a[44:47], v[208:211], v[120:135]
    buffer_load_dwordx4 v2, s[8:11], s57 offen offset:1024 lds
    ds_read_b64_tr_b16 a[164:165], v4 offset:14336
    ds_read_b64_tr_b16 a[166:167], v4 offset:14848
    v_mfma_f32_32x32x16_bf16 v[104:119], a[40:43], v[208:211], v[104:119]
    ds_read_b64_tr_b16 a[160:161], v3 offset:14336
    ds_read_b64_tr_b16 a[162:163], v3 offset:14848
    v_mfma_f32_32x32x16_bf16 v[120:135], a[52:55], v[212:215], v[120:135]
    ds_read_b64_tr_b16 a[172:173], v4 offset:16384
    ds_read_b64_tr_b16 a[174:175], v4 offset:16896
    v_mfma_f32_32x32x16_bf16 v[104:119], a[48:51], v[212:215], v[104:119]
    ds_read_b64_tr_b16 a[168:169], v3 offset:16384
    s_waitcnt vmcnt(9)
    v_max3_u32 v15, v216, v218, v220
    v_max3_u32 v15, v15, v222, v224
    v_max_u32 v15, v15, v226
    v_cmp_eq_u32 vcc, -1, v15
    s_cbranch_vccz C4_1_7K
C4_1_7R:
    buffer_load_dwordx4 v[216:219], v240, s[24:27], s39 offen sc1
    buffer_load_dwordx4 v[220:223], v240, s[24:27], s40 offen sc1
    buffer_load_dwordx4 v[224:227], v240, s[24:27], s41 offen sc1
    s_sub_u32 s73, s73, 1
    s_cbranch_scc1 END
    s_waitcnt vmcnt(0)
    v_max3_u32 v15, v216, v218, v220
    v_max3_u32 v15, v15, v222, v224
    v_max_u32 v15, v15, v226
    v_cmp_eq_u32 vcc, -1, v15
    s_cbranch_vccnz C4_1_7R
C4_1_7K:
    v_mfma_f32_32x32x16_bf16 v[120:135], a[60:63], v[216:219], v[120:135]
    ds_read_b64_tr_b16 a[170:171], v3 offset:16896
    ds_read_b64_tr_b16 a[180:181], v4 offset:18432
    ds_read_b128 v[16:19], v14 offset:160
    v_mfma_f32_32x32x16_bf16 v[104:119], a[56:59], v[216:219], v[104:119]
    ds_read_b64_tr_b16 a[182:183], v4 offset:18944
    ds_read_b64_tr_b16 a[176:177], v3 offset:18432
    v_mfma_f32_32x32x16_bf16 v[120:135], a[68:71], v[220:223], v[120:135]
    ds_read_b64_tr_b16 a[178:179], v3 offset:18944
    v_mfma_f32_32x32x16_bf16 v[104:119], a[64:67], v[220:223], v[104:119]
    ds_read_b64_tr_b16 a[140:141], v4 offset:8192
    ds_read_b64_tr_b16 a[142:143], v4 offset:8704
    v_mfma_f32_32x32x16_bf16 v[120:135], a[76:79], v[224:227], v[120:135]
    ds_read_b64_tr_b16 a[136:137], v3 offset:8192
    ds_read_b64_tr_b16 a[138:139], v3 offset:8704
    v_mfma_f32_32x32x16_bf16 v[104:119], a[72:75], v[224:227], v[104:119]
    ds_read_b64_tr_b16 a[148:149], v4 offset:10240
    ds_read_b64_tr_b16 a[150:151], v4 offset:10752
    s_waitcnt vmcnt(5)
    v_max3_u32 v15, v228, v230, v232
    v_max3_u32 v15, v15, v234, v236
    v_max_u32 v15, v15, v238
    v_cmp_eq_u32 vcc, -1, v15
    s_cbranch_vccz C4_1_10K
C4_1_10R:
    buffer_load_dwordx4 v[228:231], v240, s[24:27], s42 offen sc1
    buffer_load_dwordx4 v[232:235], v240, s[24:27], s43 offen sc1
    buffer_load_dwordx4 v[236:239], v240, s[24:27], s44 offen sc1
    s_sub_u32 s73, s73, 1
    s_cbranch_scc1 END
    s_waitcnt vmcnt(0)
    v_max3_u32 v15, v228, v230, v232
    v_max3_u32 v15, v15, v234, v236
    v_max_u32 v15, v15, v238
    v_cmp_eq_u32 vcc, -1, v15
    s_cbranch_vccnz C4_1_10R
C4_1_10K:
    v_mfma_f32_32x32x16_bf16 v[120:135], a[84:87], v[228:231], v[120:135]
    buffer_load_dwordx4 v[140:143], v11, s[24:27], s33 offen sc1
    ds_read_b64_tr_b16 a[144:145], v3 offset:10240
    v_mfma_f32_32x32x16_bf16 v[120:135], a[92:95], v[232:235], v[120:135]
    buffer_load_dwordx4 v[144:147], v11, s[24:27], s34 offen sc1
    ds_read_b64_tr_b16 a[146:147], v3 offset:10752
    ds_read_b64_tr_b16 a[156:157], v4 offset:12288
    s_waitcnt lgkmcnt(12)
    v_lshlrev_b32 v24, 16, v16
    v_and_b32 v25, 0xffff0000, v16
    v_mfma_f32_32x32x16_bf16 v[120:135], a[100:103], v[236:239], v[120:135]
    buffer_load_dwordx4 v[148:151], v11, s[24:27], s35 offen sc1
    ds_read_b64_tr_b16 a[158:159], v4 offset:12800
    ds_read_b64_tr_b16 a[152:153], v3 offset:12288
    v_lshlrev_b32 v26, 16, v17
    v_and_b32 v27, 0xffff0000, v17
    v_lshlrev_b32 v28, 16, v18
    v_mfma_f32_32x32x16_bf16 v[104:119], a[80:83], v[228:231], v[104:119]
    buffer_load_dwordx4 v[152:155], v11, s[24:27], s36 offen sc1
    ds_read_b64_tr_b16 a[154:155], v3 offset:12800
    v_add_u32 v240, 106496, v240
    v_and_b32 v29, 0xffff0000, v18
    v_lshlrev_b32 v30, 16, v19
    v_and_b32 v31, 0xffff0000, v19
    v_mfma_f32_32x32x16_bf16 v[104:119], a[88:91], v[232:235], v[104:119]
    ds_write_b128 v8, v[120:123] offset:32768
    ds_write_b128 v8, v[124:127] offset:33792
    buffer_load_dwordx4 v[156:159], v11, s[24:27], s37 offen sc1
    v_mfma_f32_32x32x16_bf16 v[104:119], a[96:99], v[236:239], v[104:119]
    ds_write_b128 v9, v[128:131] offset:40960
    ds_write_b128 v9, v[132:135] offset:41984
    buffer_load_dwordx4 v[160:163], v11, s[24:27], s38 offen sc1
    v_mfma_f32_32x32x16_bf16 v[88:103], a[108:111], v[136:139], 0
    buffer_load_dwordx4 v[164:167], v11, s[24:27], s39 offen sc1
    v_mfma_f32_32x32x16_bf16 v[72:87], a[104:107], v[136:139], v[24:39]
    s_nop 5
    ds_write_b128 v7, v[112:115] offset:24576
    ds_write_b128 v7, v[116:119] offset:25600
    buffer_load_dwordx4 v[168:171], v11, s[24:27], s40 offen sc1
    s_waitcnt vmcnt(5)
    v_max3_u32 v15, v140, v142, v144
    v_max3_u32 v15, v15, v146, v148
    v_max_u32 v15, v15, v150
    v_cmp_eq_u32 vcc, -1, v15
    v_fma_f32 v64, v48, v104, v64
    v_fma_f32 v65, v49, v105, v65
    v_fma_f32 v66, v50, v106, v66
    v_fma_f32 v67, v51, v107, v67
    v_fma_f32 v68, v52, v108, v68
    v_fma_f32 v69, v53, v109, v69
    v_fma_f32 v70, v54, v110, v70
    v_fma_f32 v71, v55, v111, v71
    s_cbranch_vccz C5_0_1K
C5_0_1R:
    buffer_load_dwordx4 v[140:143], v11, s[24:27], s33 offen sc1
    buffer_load_dwordx4 v[144:147], v11, s[24:27], s34 offen sc1
    buffer_load_dwordx4 v[148:151], v11, s[24:27], s35 offen sc1
    s_sub_u32 s73, s73, 1
    s_cbranch_scc1 END
    s_waitcnt vmcnt(0)
    v_max3_u32 v15, v140, v142, v144
    v_max3_u32 v15, v15, v146, v148
    v_max_u32 v15, v15, v150
    v_cmp_eq_u32 vcc, -1, v15
    s_cbranch_vccnz C5_0_1R
C5_0_1K:
    v_mfma_f32_32x32x16_bf16 v[88:103], a[116:119], v[140:143], v[88:103]
    buffer_load_dwordx4 v[172:175], v11, s[24:27], s41 offen sc1
    s_waitcnt lgkmcnt(0)
    s_barrier
    ds_read_b128 v[120:123], v10 offset:32768
    ds_read_b128 v[128:131], v10 offset:40960
    ds_read_b128 v[112:115], v10 offset:24576
    v_mfma_f32_32x32x16_bf16 v[72:87], a[112:115], v[140:143], v[72:87]
    ds_read_b128 v[124:127], v10 offset:33792
    ds_read_b128 v[132:135], v10 offset:41984
    ds_read_b128 v[116:119], v10 offset:25600
    buffer_load_dwordx4 v[176:179], v11, s[24:27], s42 offen sc1
    v_mfma_f32_32x32x16_bf16 v[88:103], a[124:127], v[144:147], v[88:103]
    s_waitcnt lgkmcnt(5)
    v_fma_f32 v64, v48, v120, v64
    v_fma_f32 v65, v49, v121, v65
    v_fma_f32 v66, v50, v122, v66
    v_fma_f32 v67, v51, v123, v67
    s_waitcnt lgkmcnt(4)
    v_fma_f32 v64, v48, v128, v64
    v_fma_f32 v65, v49, v129, v65
    v_fma_f32 v66, v50, v130, v66
    v_fma_f32 v67, v51, v131, v67
    s_waitcnt lgkmcnt(3)
    v_fma_f32 v64, v48, v112, v64
    buffer_load_dwordx4 v[180:183], v11, s[24:27], s43 offen sc1
    v_mfma_f32_32x32x16_bf16 v[72:87], a[120:123], v[144:147], v[72:87]
    v_fma_f32 v65, v49, v113, v65
    v_fma_f32 v66, v50, v114, v66
    v_fma_f32 v67, v51, v115, v67
    v_cvt_pk_bf16_f32 v188, v64, v65
    v_cvt_pk_bf16_f32 v189, v66, v67
    v_min_u32 v188, -2, v188
    s_waitcnt lgkmcnt(2)
    v_fma_f32 v68, v52, v124, v68
    v_fma_f32 v69, v53, v125, v69
    v_fma_f32 v70, v54, v126, v70
    v_fma_f32 v71, v55, v127, v71
    s_waitcnt lgkmcnt(1)
    buffer_load_dwordx4 v[184:187], v11, s[24:27], s44 offen sc1
    v_mfma_f32_32x32x16_bf16 v[88:103], a[132:135], v[148:151], v[88:103]
    v_fma_f32 v68, v52, v132, v68
    v_fma_f32 v69, v53, v133, v69
    v_fma_f32 v70, v54, v134, v70
    v_fma_f32 v71, v55, v135, v71
    s_waitcnt lgkmcnt(0)
    v_fma_f32 v68, v52, v116, v68
    v_fma_f32 v69, v53, v117, v69
    v_fma_f32 v70, v54, v118, v70
    v_fma_f32 v71, v55, v119, v71
    v_cvt_pk_bf16_f32 v190, v68, v69
    v_cvt_pk_bf16_f32 v191, v70, v71
    v_min_u32 v190, -2, v190
    s_cmp_lg_u32 s78, 0
    s_cbranch_scc1 DS9A
    buffer_store_dwordx4 v[188:191], v12, s[24:27], s32 offen
DS9B:
    v_subrev_u32 v12, 212992, v12
    v_mfma_f32_32x32x16_bf16 v[72:87], a[128:131], v[148:151], v[72:87]
    s_waitcnt vmcnt(7)
    v_max3_u32 v15, v152, v154, v156
    v_max3_u32 v15, v15, v158, v160
    v_max_u32 v15, v15, v162
    v_cmp_eq_u32 vcc, -1, v15
    s_cbranch_vccz C5_0_4K
C5_0_4R:
    buffer_load_dwordx4 v[152:155], v11, s[24:27], s36 offen sc1
    buffer_load_dwordx4 v[156:159], v11, s[24:27], s37 offen sc1
    buffer_load_dwordx4 v[160:163], v11, s[24:27], s38 offen sc1
    s_sub_u32 s73, s73, 1
    s_cbranch_scc1 END
    s_waitcnt vmcnt(0)
    v_max3_u32 v15, v152, v154, v156
    v_max3_u32 v15, v15, v158, v160
    v_max_u32 v15, v15, v162
    v_cmp_eq_u32 vcc, -1, v15
    s_cbranch_vccnz C5_0_4R
C5_0_4K:
    v_mfma_f32_32x32x16_bf16 v[88:103], a[140:143], v[152:155], v[88:103]
    v_mfma_f32_32x32x16_bf16 v[72:87], a[136:139], v[152:155], v[72:87]
    v_mfma_f32_32x32x16_bf16 v[88:103], a[148:151], v[156:159], v[88:103]
    ds_read_b64_tr_b16 a[188:189], v4 offset:20480
    ds_read_b64_tr_b16 a[190:191], v4 offset:20992
    v_mfma_f32_32x32x16_bf16 v[72:87], a[144:147], v[156:159], v[72:87]
    ds_read_b64_tr_b16 a[184:185], v3 offset:20480
    v_mfma_f32_32x32x16_bf16 v[88:103], a[156:159], v[160:163], v[88:103]
    ds_read_b64_tr_b16 a[186:187], v3 offset:20992
    ds_read_b64_tr_b16 a[196:197], v4 offset:22528
    v_mfma_f32_32x32x16_bf16 v[72:87], a[152:155], v[160:163], v[72:87]
    ds_read_b64_tr_b16 a[198:199], v4 offset:23040
    s_waitcnt vmcnt(4)
    v_max3_u32 v15, v164, v166, v168
    v_max3_u32 v15, v15, v170, v172
    v_max_u32 v15, v15, v174
    v_cmp_eq_u32 vcc, -1, v15
    s_cbranch_vccz C5_0_7K
C5_0_7R:
    buffer_load_dwordx4 v[164:167], v11, s[24:27], s39 offen sc1
    buffer_load_dwordx4 v[168:171], v11, s[24:27], s40 offen sc1
    buffer_load_dwordx4 v[172:175], v11, s[24:27], s41 offen sc1
    s_sub_u32 s73, s73, 1
    s_cbranch_scc1 END
    s_waitcnt vmcnt(0)
    v_max3_u32 v15, v164, v166, v168
    v_max3_u32 v15, v15, v170, v172
    v_max_u32 v15, v15, v174
    v_cmp_eq_u32 vcc, -1, v15
    s_cbranch_vccnz C5_0_7R
C5_0_7K:
    v_mfma_f32_32x32x16_bf16 v[88:103], a[164:167], v[164:167], v[88:103]
    ds_read_b64_tr_b16 a[192:193], v3 offset:22528
    ds_read_b64_tr_b16 a[194:195], v3 offset:23040
    v_mfma_f32_32x32x16_bf16 v[72:87], a[160:163], v[164:167], v[72:87]
    ds_read_b64_tr_b16 a[204:205], v4 offset:24576
    v_mfma_f32_32x32x16_bf16 v[88:103], a[172:175], v[168:171], v[88:103]
    ds_read_b64_tr_b16 a[206:207], v4 offset:25088
    ds_read_b64_tr_b16 a[200:201], v3 offset:24576
    v_mfma_f32_32x32x16_bf16 v[72:87], a[168:171], v[168:171], v[72:87]
    ds_read_b64_tr_b16 a[202:203], v3 offset:25088
    v_mfma_f32_32x32x16_bf16 v[88:103], a[180:183], v[172:175], v[88:103]
    v_mfma_f32_32x32x16_bf16 v[72:87], a[176:179], v[172:175], v[72:87]
    s_waitcnt vmcnt(1)
    v_max3_u32 v15, v176, v178, v180
    v_max3_u32 v15, v15, v182, v184
    v_max_u32 v15, v15, v186
    v_cmp_eq_u32 vcc, -1, v15
    s_cbranch_vccz C5_0_10K
C5_0_10R:
    buffer_load_dwordx4 v[176:179], v11, s[24:27], s42 offen sc1
    buffer_load_dwordx4 v[180:183], v11, s[24:27], s43 offen sc1
    buffer_load_dwordx4 v[184:187], v11, s[24:27], s44 offen sc1
    s_sub_u32 s73, s73, 1
    s_cbranch_scc1 END
    s_waitcnt vmcnt(0)
    v_max3_u32 v15, v176, v178, v180
    v_max3_u32 v15, v15, v182, v184
    v_max_u32 v15, v15, v186
    v_cmp_eq_u32 vcc, -1, v15
    s_cbranch_vccnz C5_0_10R
C5_0_10K:
    s_waitcnt lgkmcnt(10)
    v_mfma_f32_32x32x16_bf16 v[88:103], a[188:191], v[176:179], v[88:103]
    buffer_load_dwordx4 v[192:195], v240, s[24:27], s33 offen sc1
    s_waitcnt lgkmcnt(6)
    v_mfma_f32_32x32x16_bf16 v[88:103], a[196:199], v[180:183], v[88:103]
    buffer_load_dwordx4 v[196:199], v240, s[24:27], s34 offen sc1
    s_waitcnt lgkmcnt(2)
    v_mfma_f32_32x32x16_bf16 v[88:103], a[204:207], v[184:187], v[88:103]
    buffer_load_dwordx4 v[200:203], v240, s[24:27], s35 offen sc1
    v_mfma_f32_32x32x16_bf16 v[72:87], a[184:187], v[176:179], v[72:87]
    buffer_load_dwordx4 v[204:207], v240, s[24:27], s36 offen sc1
    v_mfma_f32_32x32x16_bf16 v[72:87], a[192:195], v[180:183], v[72:87]
    s_nop 7
    ds_write_b128 v8, v[88:91] offset:8192
    ds_write_b128 v8, v[92:95] offset:9216
    buffer_load_dwordx4 v[208:211], v240, s[24:27], s37 offen sc1
    s_waitcnt lgkmcnt(2)
    v_mfma_f32_32x32x16_bf16 v[72:87], a[200:203], v[184:187], v[72:87]
    ds_write_b128 v9, v[96:99] offset:16384
    ds_write_b128 v9, v[100:103] offset:17408
    buffer_load_dwordx4 v[212:215], v240, s[24:27], s38 offen sc1
    v_mfma_f32_32x32x16_bf16 v[120:135], a[108:111], v[188:191], 0
    buffer_load_dwordx4 v[216:219], v240, s[24:27], s39 offen sc1
    v_mfma_f32_32x32x16_bf16 v[104:119], a[104:107], v[188:191], v[24:39]
    s_nop 5
    ds_write_b128 v7, v[80:83] offset:0
    ds_write_b128 v7, v[84:87] offset:1024
    buffer_load_dwordx4 v[220:223], v240, s[24:27], s40 offen sc1
    s_waitcnt vmcnt(5)
    v_max3_u32 v15, v192, v194, v196
    v_max3_u32 v15, v15, v198, v200
    v_max_u32 v15, v15, v202
    v_cmp_eq_u32 vcc, -1, v15
    v_fma_f32 v56, v40, v72, v56
    v_fma_f32 v57, v41, v73, v57
    v_fma_f32 v58, v42, v74, v58
    v_fma_f32 v59, v43, v75, v59
    v_fma_f32 v60, v44, v76, v60
    v_fma_f32 v61, v45, v77, v61
    v_fma_f32 v62, v46, v78, v62
    v_fma_f32 v63, v47, v79, v63
    s_cbranch_vccz C5_1_1K
C5_1_1R:
    buffer_load_dwordx4 v[192:195], v240, s[24:27], s33 offen sc1
    buffer_load_dwordx4 v[196:199], v240, s[24:27], s34 offen sc1
    buffer_load_dwordx4 v[200:203], v240, s[24:27], s35 offen sc1
    s_sub_u32 s73, s73, 1
    s_cbranch_scc1 END
    s_waitcnt vmcnt(0)
    v_max3_u32 v15, v192, v194, v196
    v_max3_u32 v15, v15, v198, v200
    v_max_u32 v15, v15, v202
    v_cmp_eq_u32 vcc, -1, v15
    s_cbranch_vccnz C5_1_1R
C5_1_1K:
    v_mfma_f32_32x32x16_bf16 v[120:135], a[116:119], v[192:195], v[120:135]
    buffer_load_dwordx4 v[224:227], v240, s[24:27], s41 offen sc1
    s_waitcnt lgkmcnt(0)
    s_barrier
    ds_read_b128 v[88:91], v10 offset:8192
    ds_read_b128 v[96:99], v10 offset:16384
    ds_read_b128 v[80:83], v10 offset:0
    v_mfma_f32_32x32x16_bf16 v[104:119], a[112:115], v[192:195], v[104:119]
    ds_read_b128 v[92:95], v10 offset:9216
    ds_read_b128 v[100:103], v10 offset:17408
    ds_read_b128 v[84:87], v10 offset:1024
    buffer_load_dwordx4 v[228:231], v240, s[24:27], s42 offen sc1
    v_mfma_f32_32x32x16_bf16 v[120:135], a[124:127], v[196:199], v[120:135]
    s_waitcnt lgkmcnt(5)
    v_fma_f32 v56, v40, v88, v56
    v_fma_f32 v57, v41, v89, v57
    v_fma_f32 v58, v42, v90, v58
    v_fma_f32 v59, v43, v91, v59
    s_waitcnt lgkmcnt(4)
    v_fma_f32 v56, v40, v96, v56
    v_fma_f32 v57, v41, v97, v57
    v_fma_f32 v58, v42, v98, v58
    v_fma_f32 v59, v43, v99, v59
    s_waitcnt lgkmcnt(3)
    v_fma_f32 v56, v40, v80, v56
    buffer_load_dwordx4 v[232:235], v240, s[24:27], s43 offen sc1
    v_mfma_f32_32x32x16_bf16 v[104:119], a[120:123], v[196:199], v[104:119]
    v_fma_f32 v57, v41, v81, v57
    v_fma_f32 v58, v42, v82, v58
    v_fma_f32 v59, v43, v83, v59
    v_cvt_pk_bf16_f32 v136, v56, v57
    v_cvt_pk_bf16_f32 v137, v58, v59
    s_waitcnt lgkmcnt(2)
    v_fma_f32 v60, v44, v92, v60
    v_fma_f32 v61, v45, v93, v61
    v_fma_f32 v62, v46, v94, v62
    v_fma_f32 v63, v47, v95, v63
    s_waitcnt lgkmcnt(1)
    v_fma_f32 v60, v44, v100, v60
    buffer_load_dwordx4 v[236:239], v240, s[24:27], s44 offen sc1
    v_mfma_f32_32x32x16_bf16 v[120:135], a[132:135], v[200:203], v[120:135]
    v_fma_f32 v61, v45, v101, v61
    v_fma_f32 v62, v46, v102, v62
    v_fma_f32 v63, v47, v103, v63
    s_waitcnt lgkmcnt(0)
    v_fma_f32 v60, v44, v84, v60
    v_fma_f32 v61, v45, v85, v61
    v_fma_f32 v62, v46, v86, v62
    v_fma_f32 v63, v47, v87, v63
    v_cvt_pk_bf16_f32 v138, v60, v61
    v_cvt_pk_bf16_f32 v139, v62, v63
    buffer_store_dwordx4 v[136:139], v13, s[16:19], 0 offen
    v_mfma_f32_32x32x16_bf16 v[104:119], a[128:131], v[200:203], v[104:119]
    s_waitcnt vmcnt(7)
    v_max3_u32 v15, v204, v206, v208
    v_max3_u32 v15, v15, v210, v212
    v_max_u32 v15, v15, v214
    v_cmp_eq_u32 vcc, -1, v15
    s_cbranch_vccz C5_1_4K
C5_1_4R:
    buffer_load_dwordx4 v[204:207], v240, s[24:27], s36 offen sc1
    buffer_load_dwordx4 v[208:211], v240, s[24:27], s37 offen sc1
    buffer_load_dwordx4 v[212:215], v240, s[24:27], s38 offen sc1
    s_sub_u32 s73, s73, 1
    s_cbranch_scc1 END
    s_waitcnt vmcnt(0)
    v_max3_u32 v15, v204, v206, v208
    v_max3_u32 v15, v15, v210, v212
    v_max_u32 v15, v15, v214
    v_cmp_eq_u32 vcc, -1, v15
    s_cbranch_vccnz C5_1_4R
C5_1_4K:
    v_mfma_f32_32x32x16_bf16 v[120:135], a[140:143], v[204:207], v[120:135]
    v_mfma_f32_32x32x16_bf16 v[104:119], a[136:139], v[204:207], v[104:119]
    v_mfma_f32_32x32x16_bf16 v[120:135], a[148:151], v[208:211], v[120:135]
    v_mfma_f32_32x32x16_bf16 v[104:119], a[144:147], v[208:211], v[104:119]
    v_mfma_f32_32x32x16_bf16 v[120:135], a[156:159], v[212:215], v[120:135]
    v_mfma_f32_32x32x16_bf16 v[104:119], a[152:155], v[212:215], v[104:119]
    s_waitcnt vmcnt(4)
    v_max3_u32 v15, v216, v218, v220
    v_max3_u32 v15, v15, v222, v224
    v_max_u32 v15, v15, v226
    v_cmp_eq_u32 vcc, -1, v15
    s_cbranch_vccz C5_1_7K
C5_1_7R:
    buffer_load_dwordx4 v[216:219], v240, s[24:27], s39 offen sc1
    buffer_load_dwordx4 v[220:223], v240, s[24:27], s40 offen sc1
    buffer_load_dwordx4 v[224:227], v240, s[24:27], s41 offen sc1
    s_sub_u32 s73, s73, 1
    s_cbranch_scc1 END
    s_waitcnt vmcnt(0)
    v_max3_u32 v15, v216, v218, v220
    v_max3_u32 v15, v15, v222, v224
    v_max_u32 v15, v15, v226
    v_cmp_eq_u32 vcc, -1, v15
    s_cbranch_vccnz C5_1_7R
C5_1_7K:
    v_mfma_f32_32x32x16_bf16 v[120:135], a[164:167], v[216:219], v[120:135]
    v_mfma_f32_32x32x16_bf16 v[104:119], a[160:163], v[216:219], v[104:119]
    v_mfma_f32_32x32x16_bf16 v[120:135], a[172:175], v[220:223], v[120:135]
    v_mfma_f32_32x32x16_bf16 v[104:119], a[168:171], v[220:223], v[104:119]
    v_mfma_f32_32x32x16_bf16 v[120:135], a[180:183], v[224:227], v[120:135]
    v_mfma_f32_32x32x16_bf16 v[104:119], a[176:179], v[224:227], v[104:119]
    s_waitcnt vmcnt(1)
    v_max3_u32 v15, v228, v230, v232
    v_max3_u32 v15, v15, v234, v236
    v_max_u32 v15, v15, v238
    v_cmp_eq_u32 vcc, -1, v15
    s_cbranch_vccz C5_1_10K
C5_1_10R:
    buffer_load_dwordx4 v[228:231], v240, s[24:27], s42 offen sc1
    buffer_load_dwordx4 v[232:235], v240, s[24:27], s43 offen sc1
    buffer_load_dwordx4 v[236:239], v240, s[24:27], s44 offen sc1
    s_sub_u32 s73, s73, 1
    s_cbranch_scc1 END
    s_waitcnt vmcnt(0)
    v_max3_u32 v15, v228, v230, v232
    v_max3_u32 v15, v15, v234, v236
    v_max_u32 v15, v15, v238
    v_cmp_eq_u32 vcc, -1, v15
    s_cbranch_vccnz C5_1_10R
C5_1_10K:
    v_mfma_f32_32x32x16_bf16 v[120:135], a[188:191], v[228:231], v[120:135]
    v_mfma_f32_32x32x16_bf16 v[120:135], a[196:199], v[232:235], v[120:135]
    v_mfma_f32_32x32x16_bf16 v[120:135], a[204:207], v[236:239], v[120:135]
    s_or_b32 s3, s28, s29
    s_lshl_b32 s3, s3, 28
    v_mov_b32 v15, s3
    s_mov_b64 exec, 1
    buffer_store_dword v252, v15, s[24:27], s76 offen offset:1920
    s_mov_b64 exec, -1
    s_nop 3
    v_mfma_f32_32x32x16_bf16 v[104:119], a[184:187], v[228:231], v[104:119]
    v_mfma_f32_32x32x16_bf16 v[104:119], a[192:195], v[232:235], v[104:119]
    ds_write_b128 v8, v[120:123] offset:32768
    ds_write_b128 v8, v[124:127] offset:33792
    v_mfma_f32_32x32x16_bf16 v[104:119], a[200:203], v[236:239], v[104:119]
    ds_write_b128 v9, v[128:131] offset:40960
    ds_write_b128 v9, v[132:135] offset:41984
    s_nop 7
    s_nop 1
    ds_write_b128 v7, v[112:115] offset:24576
    ds_write_b128 v7, v[116:119] offset:25600
    v_fma_f32 v64, v48, v104, v64
    v_fma_f32 v65, v49, v105, v65
    v_fma_f32 v66, v50, v106, v66
    v_fma_f32 v67, v51, v107, v67
    v_fma_f32 v68, v52, v108, v68
    v_fma_f32 v69, v53, v109, v69
    v_fma_f32 v70, v54, v110, v70
    v_fma_f32 v71, v55, v111, v71
    s_waitcnt lgkmcnt(0)
    s_barrier
    ds_read_b128 v[120:123], v10 offset:32768
    ds_read_b128 v[128:131], v10 offset:40960
    ds_read_b128 v[112:115], v10 offset:24576
    ds_read_b128 v[124:127], v10 offset:33792
    ds_read_b128 v[132:135], v10 offset:41984
    ds_read_b128 v[116:119], v10 offset:25600
    s_waitcnt lgkmcnt(5)
    v_fma_f32 v64, v48, v120, v64
    v_fma_f32 v65, v49, v121, v65
    v_fma_f32 v66, v50, v122, v66
    v_fma_f32 v67, v51, v123, v67
    s_waitcnt lgkmcnt(4)
    v_fma_f32 v64, v48, v128, v64
    v_fma_f32 v65, v49, v129, v65
    v_fma_f32 v66, v50, v130, v66
    v_fma_f32 v67, v51, v131, v67
    s_waitcnt lgkmcnt(3)
    v_fma_f32 v64, v48, v112, v64
    v_fma_f32 v65, v49, v113, v65
    v_fma_f32 v66, v50, v114, v66
    v_fma_f32 v67, v51, v115, v67
    v_cvt_pk_bf16_f32 v188, v64, v65
    v_cvt_pk_bf16_f32 v189, v66, v67
    s_waitcnt lgkmcnt(2)
    v_fma_f32 v68, v52, v124, v68
    v_fma_f32 v69, v53, v125, v69
    v_fma_f32 v70, v54, v126, v70
    v_fma_f32 v71, v55, v127, v71
    s_waitcnt lgkmcnt(1)
    v_fma_f32 v68, v52, v132, v68
    v_fma_f32 v69, v53, v133, v69
    v_fma_f32 v70, v54, v134, v70
    v_fma_f32 v71, v55, v135, v71
    s_waitcnt lgkmcnt(0)
    v_fma_f32 v68, v52, v116, v68
    v_fma_f32 v69, v53, v117, v69
    v_fma_f32 v70, v54, v118, v70
    v_fma_f32 v71, v55, v119, v71
    v_cvt_pk_bf16_f32 v190, v68, v69
    v_cvt_pk_bf16_f32 v191, v70, v71
    buffer_store_dwordx4 v[188:191], v13, s[16:19], s77 offen
END:
    s_endpgm
FRT:
    buffer_load_dwordx2 v[20:21], v254, s[24:27], s76 offen sc1
    s_waitcnt vmcnt(0)
    s_sub_u32 s73, s73, 1
    s_cbranch_scc1 END
    s_branch FCK
DS0A:
    buffer_store_dwordx4 v[136:139], v12, s[24:27], s32 offen sc1
    s_branch DS0B
PS2A:
    buffer_store_dwordx4 v[248:251], v243, s[24:27], s32 offen sc1
    s_branch PS2B
DS1A:
    buffer_store_dwordx4 v[188:191], v12, s[24:27], s32 offen sc1
    s_branch DS1B
PS3A:
    buffer_store_dwordx4 v[248:251], v243, s[24:27], s32 offen sc1
    s_branch PS3B
DS2A:
    buffer_store_dwordx4 v[136:139], v12, s[24:27], s32 offen sc1
    s_branch DS2B
PS4A:
    buffer_store_dwordx4 v[248:251], v243, s[24:27], s32 offen sc1
    s_branch PS4B
DS3A:
    buffer_store_dwordx4 v[188:191], v12, s[24:27], s32 offen sc1
    s_branch DS3B
PS5A:
    buffer_store_dwordx4 v[248:251], v243, s[24:27], s32 offen sc1
    s_branch PS5B
DS4A:
    buffer_store_dwordx4 v[136:139], v12, s[24:27], s32 offen sc1
    s_branch DS4B
PS6A:
    buffer_store_dwordx4 v[248:251], v243, s[24:27], s32 offen sc1
    s_branch PS6B
DS5A:
    buffer_store_dwordx4 v[188:191], v12, s[24:27], s32 offen sc1
    s_branch DS5B
PS7A:
    buffer_store_dwordx4 v[248:251], v243, s[24:27], s32 offen sc1
    s_branch PS7B
DS6A:
    buffer_store_dwordx4 v[136:139], v12, s[24:27], s32 offen sc1
    s_branch DS6B
PS8A:
    buffer_store_dwordx4 v[248:251], v243, s[24:27], s32 offen sc1
    s_branch PS8B
DS7A:
    buffer_store_dwordx4 v[188:191], v12, s[24:27], s32 offen sc1
    s_branch DS7B
PS9A:
    buffer_store_dwordx4 v[248:251], v243, s[24:27], s32 offen sc1
    s_branch PS9B
DS8A:
    buffer_store_dwordx4 v[136:139], v12, s[24:27], s32 offen sc1
    s_branch DS8B
DS9A:
    buffer_store_dwordx4 v[188:191], v12, s[24:27], s32 offen sc1
    s_branch DS9B
HELPER:
    s_cmp_ge_u32 s2, 256
    s_cbranch_scc1 END
    s_load_dwordx2 s[8:9], s[0:1], 8
    v_lshrrev_b32 v1, 6, v0
    v_and_b32 v0, 63, v0
    v_readfirstlane_b32 s28, v1
    s_mov_b32 s10, 8306688
    s_mov_b32 s11, 0x20000
    s_sub_u32 s3, s2, 208
    s_lshr_b32 s3, s3, 3
    s_lshl_b32 s3, s3, 2
    s_add_u32 s3, s3, s28
    s_bfe_u32 s4, s2, 0x20001
    v_add_u32 v2, s4, v0
    v_and_b32 v2, 3, v2
    v_mul_u32_u24 v4, 24, v2
    v_add_u32 v4, s3, v4
    v_lshrrev_b32 v10, 3, v0
    v_and_b32 v10, 1, v10
    v_mad_u32_u24 v4, v10, 13, v4
    v_min_u32 v4, 90, v4
    v_mul_u32_u24 v5, 79, v4
    v_lshrrev_b32 v5, 10, v5
    v_mul_u32_u24 v6, 13, v5
    v_sub_u32 v6, v4, v6
    s_movk_i32 s4, 3510
    v_lshrrev_b32 v7, v6, s4
    v_lshrrev_b32 v3, 2, v0
    v_and_b32 v7, v7, v3
    v_xor_b32 v7, s2, v7
    v_xor_b32 v7, v10, v7
    v_and_b32 v7, 1, v7
    v_cmp_eq_u32 vcc, 1, v7
    v_mov_b32 v3, 0xc9b8a70
    v_mov_b32 v7, 0x6352410
    v_cndmask_b32 v3, v3, v7, vcc
    v_lshlrev_b32 v5, 2, v5
    v_lshrrev_b32 v5, v5, v3
    v_and_b32 v5, 15, v5
    v_add_u32 v5, v5, v6
    v_subrev_u32 v7, 13, v5
    v_min_u32 v5, v5, v7
    s_mov_b32 s5, 106496
    v_mul_lo_u32 v3, v5, s5
    v_lshl_add_u32 v3, v6, 7, v3
    v_mul_u32_u24 v8, 1664, v0
    v_readlane_b32 s36, v3, 4
    v_readlane_b32 s37, v3, 5
    v_readlane_b32 s38, v3, 6
    v_readlane_b32 s39, v3, 7
    v_readlane_b32 s32, v3, 0
    v_readlane_b32 s33, v3, 1
    v_readlane_b32 s34, v3, 2
    v_readlane_b32 s35, v3, 3
    s_waitcnt lgkmcnt(0)
    buffer_load_dword v9, v8, s[8:11], s36 offen
    s_add_u32 s4, s32, 1384448
    buffer_load_dword v9, v8, s[8:11], s4 offen
    buffer_load_dword v9, v8, s[8:11], s37 offen
    buffer_load_dword v9, v8, s[8:11], s38 offen
    buffer_load_dword v9, v8, s[8:11], s39 offen
    s_add_u32 s4, s32, 2768896
    buffer_load_dword v9, v8, s[8:11], s4 offen
    s_add_u32 s4, s33, 1384448
    buffer_load_dword v9, v8, s[8:11], s4 offen
    s_add_u32 s4, s34, 1384448
    buffer_load_dword v9, v8, s[8:11], s4 offen
    s_add_u32 s4, s35, 1384448
    buffer_load_dword v9, v8, s[8:11], s4 offen
    s_add_u32 s4, s32, 4153344
    buffer_load_dword v9, v8, s[8:11], s4 offen
    s_add_u32 s4, s33, 2768896
    buffer_load_dword v9, v8, s[8:11], s4 offen
    s_add_u32 s4, s34, 2768896
    buffer_load_dword v9, v8, s[8:11], s4 offen
    s_add_u32 s4, s35, 2768896
    buffer_load_dword v9, v8, s[8:11], s4 offen
    s_add_u32 s4, s32, 5537792
    buffer_load_dword v9, v8, s[8:11], s4 offen
    s_add_u32 s4, s33, 4153344
    buffer_load_dword v9, v8, s[8:11], s4 offen
    s_add_u32 s4, s34, 4153344
    buffer_load_dword v9, v8, s[8:11], s4 offen
    s_add_u32 s4, s35, 4153344
    buffer_load_dword v9, v8, s[8:11], s4 offen
    s_add_u32 s4, s32, 6922240
    buffer_load_dword v9, v8, s[8:11], s4 offen
    s_add_u32 s4, s33, 5537792
    buffer_load_dword v9, v8, s[8:11], s4 offen
    s_add_u32 s4, s34, 5537792
    buffer_load_dword v9, v8, s[8:11], s4 offen
    s_add_u32 s4, s35, 5537792
    buffer_load_dword v9, v8, s[8:11], s4 offen
    s_add_u32 s4, s33, 6922240
    buffer_load_dword v9, v8, s[8:11], s4 offen
    s_add_u32 s4, s34, 6922240
    buffer_load_dword v9, v8, s[8:11], s4 offen
    s_add_u32 s4, s35, 6922240
    buffer_load_dword v9, v8, s[8:11], s4 offen
    s_waitcnt vmcnt(0)
    s_endpgm
    s_endpgm
.section .rodata,"a"
.p2align 6
.amdhsa_kernel standalone__cross_network_dcn__recsys_kernel
  .amdhsa_next_free_vgpr 464
  .amdhsa_next_free_sgpr 102
  .amdhsa_accum_offset 256
  .amdhsa_group_segment_fixed_size 0
  .amdhsa_kernarg_size 48
  .amdhsa_user_sgpr_count 2
  .amdhsa_user_sgpr_kernarg_segment_ptr 1
  .amdhsa_system_sgpr_workgroup_id_x 1
.end_amdhsa_kernel
```
